```python
import torch

def _softmax(x, axis=-1):
    return torch.softmax(x, dim=axis)
def _gelu(x):
    return torch.nn.functional.gelu(x, approximate="tanh")
def _silu(x):
    return torch.nn.functional.silu(x)
def _sigmoid(x):
    return torch.sigmoid(x)
def _layernorm(x, axis=-1, eps=1e-5):
    m = x.mean(dim=axis, keepdim=True)
    v = x.var(dim=axis, keepdim=True, unbiased=False)
    return (x - m) / torch.sqrt(v + eps)
def _scatter_add(tgt, idx, src, axis=0):
    return tgt.clone().index_add_(axis, idx, src)
def _segment_sum(src, seg, n):
    out = torch.zeros((n,) + src.shape[1:], dtype=src.dtype)
    return out.index_add_(0, seg, src)
def _pad(x, pw):
    flat = tuple(v for pair in reversed(pw) for v in pair)
    return torch.nn.functional.pad(x, flat)

kernel_name = 'standalone__mha_block_cached__sampling'

def setup_inputs():

    _w = (lambda a: (lambda t: t.to(torch.bfloat16) if t.is_floating_point() else t)(torch.as_tensor(a)))
    B, Sq, D = 8, 1, 640
    H, Sk, Dh = 32, 4096, 192
    return {
        "x": _w((lambda *s: torch.randn(*s, dtype=torch.bfloat16) * 0.8)(B, Sq, D)),
        "k_cache": _w((lambda *s: torch.randn(*s, dtype=torch.bfloat16) * 0.8)(B, H, Sk, Dh)),
        "v_cache": _w((lambda *s: torch.randn(*s, dtype=torch.bfloat16) * 0.05)(B, H, Sk, Dh)),
        "wq": _w((lambda *s: torch.randn(*s, dtype=torch.bfloat16) * 0.8)(D, H * Dh) * (D ** -0.5)),
        "wo": _w((lambda *s: torch.randn(*s, dtype=torch.bfloat16) * 0.05)(H * Dh, D) * ((H * Dh) ** -0.5)),
    }

def reference(x, k_cache, v_cache, wq, wo):
    B, Sq, D = x.shape
    H, Dh = 32, 192
    q = (lambda x, *d: x.permute(*d))((x @ wq).reshape(B, Sq, H, Dh), 0, 2, 1, 3)
    scores = torch.einsum("bhqd,bhkd->bhqk", q, k_cache) * (Dh ** -0.5)
    p = _softmax(scores, axis=-1)
    o = torch.einsum("bhqk,bhkd->bhqd", p, v_cache)
    return (lambda x, *d: x.permute(*d))(o, 0, 2, 1, 3).reshape(B, Sq, H * Dh) @ wo
```

```asm
; @launch grid=(256,1,1) block=(320,1,1) lds=161408
.amdgcn_target "amdgcn-amd-amdhsa--gfx950"
.text
.globl standalone__mha_block_cached__sampling_kernel
.p2align 8
.type standalone__mha_block_cached__sampling_kernel,@function
standalone__mha_block_cached__sampling_kernel:
    s_cmp_ge_u32 s2, 256
    s_cbranch_scc1 L_end
    s_load_dwordx16 s[4:19], s[0:1], 0
    v_lshrrev_b32 v1, 6, v0
    v_and_b32 v0, 63, v0
    v_readfirstlane_b32 s3, v1
    s_lshr_b32 s40, s2, 5
    s_and_b32 s41, s2, 31
    s_mov_b32 s35, 0x20000
    s_mov_b32 s39, 0x20000
    s_mov_b32 s31, 0x20000
    s_mov_b32 s30, 761856
    s_mov_b32 s38, 10240
    s_cmp_lg_u32 s3, 0
    s_cbranch_scc1 L_nopre
    s_getpc_b64 s[76:77]
L_pc:
    s_add_u32 s76, s76, standalone__mha_block_cached__sampling_kernel-L_pc
    s_addc_u32 s77, s77, -1
    v_lshlrev_b32 v240, 7, v0
    v_min_u32 v241, L_end-standalone__mha_block_cached__sampling_kernel, v240
    global_load_dword v242, v241, s[76:77]
    v_add_u32 v240, 8192, v240
    v_min_u32 v241, L_end-standalone__mha_block_cached__sampling_kernel, v240
    global_load_dword v243, v241, s[76:77]
L_nopre:
    s_cmp_eq_u32 s3, 4
    s_cbranch_scc1 L_loader
    v_lshrrev_b32 v48, 3, v0
    v_and_b32 v49, 7, v0
    v_lshrrev_b32 v50, 4, v0
    v_and_b32 v51, 15, v0
    v_mul_u32_u24 v60, 49152, v50
    v_lshl_add_u32 v60, v51, 4, v60
    v_add_u32 v62, 24704, v60
    v_add_u32 v61, 256, v60
    v_add_u32 v52, 24448, v60
    v_cmp_gt_u32 vcc, 8, v51
    v_lshlrev_b32 v63, 2, v48
    s_mul_i32 s65, s40, 1280
    v_cndmask_b32 v61, v52, v61, vcc
    s_lshl_b32 s66, s3, 5
    s_add_u32 s79, s65, s66
    s_mul_i32 s62, s40, 10
    s_lshr_b32 s62, s62, 3
    s_mul_i32 s66, s3, 196608
    s_mul_i32 s67, s41, 384
    s_add_u32 s66, s66, s67
    s_sub_u32 s34, 7864320, s66
    s_waitcnt lgkmcnt(0)
    s_mov_b32 s28, s18
    s_mov_b32 s29, s19
    s_mov_b32 s36, s4
    s_mov_b32 s37, s5
    s_add_u32 s32, s10, s66
    s_addc_u32 s33, s11, 0
    s_cmp_lt_u32 s2, 32
    s_cbranch_scc1 L_init
L_noinit:
    s_lshl_b32 s73, s62, 7
    s_add_u32 s73, s73, s79
    s_mul_i32 s72, s62, 786432
    buffer_load_dword v36, v63, s[36:39], s73 offen
    s_add_u32 s62, s62, 1
    s_cmp_eq_u32 s62, 10
    s_cselect_b32 s62, 0, s62
    buffer_load_dwordx4 v[64:67], v60, s[32:35], s72 offen
    buffer_load_dwordx4 v[68:71], v61, s[32:35], s72 offen
    buffer_load_dwordx4 v[72:75], v62, s[32:35], s72 offen
    s_add_u32 s72, s72, 12288
    buffer_load_dwordx4 v[76:79], v60, s[32:35], s72 offen
    buffer_load_dwordx4 v[80:83], v61, s[32:35], s72 offen
    buffer_load_dwordx4 v[84:87], v62, s[32:35], s72 offen
    s_lshl_b32 s73, s62, 7
    s_add_u32 s73, s73, s79
    s_mul_i32 s72, s62, 786432
    buffer_load_dword v37, v63, s[36:39], s73 offen
    s_add_u32 s62, s62, 1
    s_cmp_eq_u32 s62, 10
    s_cselect_b32 s62, 0, s62
    buffer_load_dwordx4 v[88:91], v60, s[32:35], s72 offen
    buffer_load_dwordx4 v[92:95], v61, s[32:35], s72 offen
    buffer_load_dwordx4 v[96:99], v62, s[32:35], s72 offen
    s_branch L_rest
L_loader:
    v_lshlrev_b32 v1, 4, v0
    s_mul_i32 s72, s2, 1572864
    s_mul_hi_u32 s73, s2, 1572864
    s_mov_b32 s50, s2
    v_add_u32 v28, s50, v0
    v_and_b32 v28, 255, v28
    v_and_b32 v29, 63, v28
    v_lshlrev_b32 v28, 1, v28
    v_sub_u32 v28, v28, v29
    v_cmp_le_u32 s[74:75], 21, v29
    v_cmp_le_u32 vcc, 43, v29
    v_add_u32 v26, 21, v28
    v_add_u32 v30, 64, v28
    v_add_u32 v31, 43, v28
    v_cndmask_b32 v26, v26, v30, vcc
    v_cndmask_b32 v27, v28, v31, s[74:75]
    v_mul_u32_u24 v26, 3072, v26
    v_mul_u32_u24 v27, 3072, v27
    s_add_u32 s50, s50, 64
    s_mov_b32 s52, 0
    v_readlane_b32 s53, v26, s52
    v_readlane_b32 s54, v27, s52
    s_add_u32 s52, s52, 1
    s_and_b32 s52, s52, 63
    s_nop 2
    s_mov_b32 s23, 0x20000
    s_mov_b32 s22, 1572864
    v_mov_b32 v46, 161344
    v_mov_b32 v12, 0
    v_mov_b32 v13, 0
    v_mov_b32 v14, 0
    v_mov_b32 v15, 0
    v_mov_b32 v47, 0
    v_mov_b32 v17, 1
    s_mov_b32 s47, 0
    s_mov_b32 s48, 0
    ds_write_b128 v46, v[12:15]
    ds_write_b128 v46, v[12:15] offset:16
    ds_write_b128 v46, v[12:15] offset:32
    ds_write_b32 v46, v17 offset:8
    s_waitcnt lgkmcnt(0)
    s_add_u32 s24, s6, s72
    s_addc_u32 s25, s7, s73
    s_add_u32 s26, s8, s72
    s_addc_u32 s27, s9, s73
    s_mov_b32 s20, s24
    s_mov_b32 s21, s25
    s_bitcmp1_b32 s2, 7
    s_cbranch_scc1 L_cb1
    s_barrier
L_cb1:
    s_add_u32 m0, s47, 0
    s_nop 0
    buffer_load_dwordx4 v1, s[20:23], s53 offen offset:0 nt lds
    buffer_load_dwordx4 v1, s[20:23], s53 offen offset:1024 nt lds
    buffer_load_dwordx4 v1, s[20:23], s53 offen offset:2048 nt lds
    s_add_u32 m0, s47, 3072
    s_nop 0
    buffer_load_dwordx4 v1, s[20:23], s54 offen offset:0 nt lds
    buffer_load_dwordx4 v1, s[20:23], s54 offen offset:1024 nt lds
    buffer_load_dwordx4 v1, s[20:23], s54 offen offset:2048 nt lds
    v_readlane_b32 s56, v26, s52
    v_readlane_b32 s57, v27, s52
    s_add_u32 s52, s52, 1
    s_and_b32 s52, s52, 63
    s_nop 2
    s_add_u32 m0, s47, 6144
    s_nop 0
    buffer_load_dwordx4 v1, s[20:23], s56 offen offset:0 nt lds
    buffer_load_dwordx4 v1, s[20:23], s56 offen offset:1024 nt lds
    buffer_load_dwordx4 v1, s[20:23], s56 offen offset:2048 nt lds
    s_add_u32 m0, s47, 9216
    s_nop 0
    buffer_load_dwordx4 v1, s[20:23], s57 offen offset:0 nt lds
    buffer_load_dwordx4 v1, s[20:23], s57 offen offset:1024 nt lds
    buffer_load_dwordx4 v1, s[20:23], s57 offen offset:2048 nt lds
    v_readlane_b32 s53, v26, s52
    v_readlane_b32 s54, v27, s52
    s_add_u32 s52, s52, 1
    s_and_b32 s52, s52, 63
    s_nop 2
    s_add_u32 m0, s47, 12288
    s_nop 0
    buffer_load_dwordx4 v1, s[20:23], s53 offen offset:0 nt lds
    buffer_load_dwordx4 v1, s[20:23], s53 offen offset:1024 nt lds
    buffer_load_dwordx4 v1, s[20:23], s53 offen offset:2048 nt lds
    s_add_u32 m0, s47, 15360
    s_nop 0
    buffer_load_dwordx4 v1, s[20:23], s54 offen offset:0 nt lds
    buffer_load_dwordx4 v1, s[20:23], s54 offen offset:1024 nt lds
    buffer_load_dwordx4 v1, s[20:23], s54 offen offset:2048 nt lds
    v_readlane_b32 s56, v26, s52
    v_readlane_b32 s57, v27, s52
    s_add_u32 s52, s52, 1
    s_and_b32 s52, s52, 63
    s_nop 2
    s_add_u32 m0, s47, 18432
    s_nop 0
    buffer_load_dwordx4 v1, s[20:23], s56 offen offset:0 nt lds
    buffer_load_dwordx4 v1, s[20:23], s56 offen offset:1024 nt lds
    buffer_load_dwordx4 v1, s[20:23], s56 offen offset:2048 nt lds
    s_add_u32 m0, s47, 21504
    s_nop 0
    buffer_load_dwordx4 v1, s[20:23], s57 offen offset:0 nt lds
    buffer_load_dwordx4 v1, s[20:23], s57 offen offset:1024 nt lds
    buffer_load_dwordx4 v1, s[20:23], s57 offen offset:2048 nt lds
    s_add_u32 s47, s47, 24576
    s_cmp_eq_u32 s47, 122880
    s_cselect_b32 s47, 0, s47
    v_readlane_b32 s53, v26, s52
    v_readlane_b32 s54, v27, s52
    s_add_u32 s52, s52, 1
    s_and_b32 s52, s52, 63
    s_nop 2
    s_mov_b32 s28, s18
    s_mov_b32 s29, s19
    s_mov_b32 s36, s14
    s_mov_b32 s37, s15
    s_mul_i32 s65, s41, 245760
    s_mul_i32 s67, s40, 160
    s_add_u32 s65, s65, s67
    s_add_u32 s32, s12, s65
    s_addc_u32 s33, s13, 0
    s_sub_u32 s34, 7864320, s65
    v_add_u32 v2, 0, v0
    v_mul_u32_u24 v3, 6554, v2
    v_lshrrev_b32 v3, 16, v3
    v_mul_u32_u24 v3, 1120, v3
    v_lshl_add_u32 v20, v2, 4, v3
    v_add_u32 v2, 64, v0
    v_mul_u32_u24 v3, 6554, v2
    v_lshrrev_b32 v3, 16, v3
    v_mul_u32_u24 v3, 1120, v3
    v_lshl_add_u32 v21, v2, 4, v3
    v_add_u32 v2, 128, v0
    v_mul_u32_u24 v3, 6554, v2
    v_lshrrev_b32 v3, 16, v3
    v_mul_u32_u24 v3, 1120, v3
    v_lshl_add_u32 v22, v2, 4, v3
    v_add_u32 v2, 192, v0
    v_mul_u32_u24 v3, 6554, v2
    v_lshrrev_b32 v3, 16, v3
    v_mul_u32_u24 v3, 1120, v3
    v_lshl_add_u32 v23, v2, 4, v3
    v_add_u32 v2, 256, v0
    v_mul_u32_u24 v3, 6554, v2
    v_lshrrev_b32 v3, 16, v3
    v_mul_u32_u24 v3, 1120, v3
    v_lshl_add_u32 v24, v2, 4, v3
    s_add_u32 m0, s47, 0
    s_nop 0
    buffer_load_dwordx4 v1, s[20:23], s53 offen offset:0 nt lds
    buffer_load_dwordx4 v1, s[20:23], s53 offen offset:1024 nt lds
    buffer_load_dwordx4 v1, s[20:23], s53 offen offset:2048 nt lds
    s_add_u32 m0, s47, 3072
    s_nop 0
    buffer_load_dwordx4 v1, s[20:23], s54 offen offset:0 nt lds
    buffer_load_dwordx4 v1, s[20:23], s54 offen offset:1024 nt lds
    buffer_load_dwordx4 v1, s[20:23], s54 offen offset:2048 nt lds
    v_readlane_b32 s56, v26, s52
    v_readlane_b32 s57, v27, s52
    s_add_u32 s52, s52, 1
    s_and_b32 s52, s52, 63
    s_nop 2
    s_add_u32 m0, s47, 6144
    s_nop 0
    buffer_load_dwordx4 v1, s[20:23], s56 offen offset:0 nt lds
    buffer_load_dwordx4 v1, s[20:23], s56 offen offset:1024 nt lds
    buffer_load_dwordx4 v1, s[20:23], s56 offen offset:2048 nt lds
    s_add_u32 m0, s47, 9216
    s_nop 0
    buffer_load_dwordx4 v1, s[20:23], s57 offen offset:0 nt lds
    buffer_load_dwordx4 v1, s[20:23], s57 offen offset:1024 nt lds
    buffer_load_dwordx4 v1, s[20:23], s57 offen offset:2048 nt lds
    v_readlane_b32 s53, v26, s52
    v_readlane_b32 s54, v27, s52
    s_add_u32 s52, s52, 1
    s_and_b32 s52, s52, 63
    s_nop 2
    s_add_u32 m0, s47, 12288
    s_nop 0
    buffer_load_dwordx4 v1, s[20:23], s53 offen offset:0 nt lds
    buffer_load_dwordx4 v1, s[20:23], s53 offen offset:1024 nt lds
    buffer_load_dwordx4 v1, s[20:23], s53 offen offset:2048 nt lds
    s_add_u32 m0, s47, 15360
    s_nop 0
    buffer_load_dwordx4 v1, s[20:23], s54 offen offset:0 nt lds
    s_waitcnt vmcnt(39)
    buffer_load_dwordx4 v1, s[20:23], s54 offen offset:1024 nt lds
    s_waitcnt vmcnt(39)
    buffer_load_dwordx4 v1, s[20:23], s54 offen offset:2048 nt lds
    v_readlane_b32 s56, v26, s52
    v_readlane_b32 s57, v27, s52
    s_add_u32 s52, s52, 1
    s_and_b32 s52, s52, 63
    s_nop 2
    s_add_u32 m0, s47, 18432
    s_waitcnt vmcnt(39)
    buffer_load_dwordx4 v1, s[20:23], s56 offen offset:0 nt lds
    s_waitcnt vmcnt(39)
    buffer_load_dwordx4 v1, s[20:23], s56 offen offset:1024 nt lds
    s_waitcnt vmcnt(39)
    buffer_load_dwordx4 v1, s[20:23], s56 offen offset:2048 nt lds
    s_add_u32 m0, s47, 21504
    s_waitcnt vmcnt(39)
    buffer_load_dwordx4 v1, s[20:23], s57 offen offset:0 nt lds
    v_add_u32 v47, 1, v47
    ds_write_b32 v46, v47 offset:0
    s_waitcnt vmcnt(39)
    buffer_load_dwordx4 v1, s[20:23], s57 offen offset:1024 nt lds
    s_waitcnt vmcnt(39)
    buffer_load_dwordx4 v1, s[20:23], s57 offen offset:2048 nt lds
    s_add_u32 s47, s47, 24576
    s_cmp_eq_u32 s47, 122880
    s_cselect_b32 s47, 0, s47
    v_readlane_b32 s53, v26, s52
    v_readlane_b32 s54, v27, s52
    s_add_u32 s52, s52, 1
    s_and_b32 s52, s52, 63
    s_nop 2
    s_add_u32 m0, s47, 0
    s_waitcnt vmcnt(39)
    buffer_load_dwordx4 v1, s[20:23], s53 offen offset:0 nt lds
    s_waitcnt vmcnt(39)
    buffer_load_dwordx4 v1, s[20:23], s53 offen offset:1024 nt lds
    s_waitcnt vmcnt(39)
    buffer_load_dwordx4 v1, s[20:23], s53 offen offset:2048 nt lds
    s_add_u32 m0, s47, 3072
    s_waitcnt vmcnt(39)
    buffer_load_dwordx4 v1, s[20:23], s54 offen offset:0 nt lds
    v_add_u32 v47, 1, v47
    ds_write_b32 v46, v47 offset:0
    s_waitcnt vmcnt(39)
    buffer_load_dwordx4 v1, s[20:23], s54 offen offset:1024 nt lds
    s_waitcnt vmcnt(39)
    buffer_load_dwordx4 v1, s[20:23], s54 offen offset:2048 nt lds
    v_readlane_b32 s56, v26, s52
    v_readlane_b32 s57, v27, s52
    s_add_u32 s52, s52, 1
    s_and_b32 s52, s52, 63
    s_nop 2
    s_add_u32 m0, s47, 6144
    s_waitcnt vmcnt(39)
    buffer_load_dwordx4 v1, s[20:23], s56 offen offset:0 nt lds
    s_waitcnt vmcnt(39)
    buffer_load_dwordx4 v1, s[20:23], s56 offen offset:1024 nt lds
    s_waitcnt vmcnt(39)
    buffer_load_dwordx4 v1, s[20:23], s56 offen offset:2048 nt lds
    s_add_u32 m0, s47, 9216
    s_waitcnt vmcnt(39)
    buffer_load_dwordx4 v1, s[20:23], s57 offen offset:0 nt lds
    v_add_u32 v47, 1, v47
    ds_write_b32 v46, v47 offset:0
    s_waitcnt vmcnt(39)
    buffer_load_dwordx4 v1, s[20:23], s57 offen offset:1024 nt lds
    s_waitcnt vmcnt(39)
    buffer_load_dwordx4 v1, s[20:23], s57 offen offset:2048 nt lds
    v_readlane_b32 s53, v26, s52
    v_readlane_b32 s54, v27, s52
    s_add_u32 s52, s52, 1
    s_and_b32 s52, s52, 63
    s_nop 2
    s_add_u32 m0, s47, 12288
    s_waitcnt vmcnt(39)
    buffer_load_dwordx4 v1, s[20:23], s53 offen offset:0 nt lds
    s_waitcnt vmcnt(39)
    buffer_load_dwordx4 v1, s[20:23], s53 offen offset:1024 nt lds
    s_waitcnt vmcnt(39)
    buffer_load_dwordx4 v1, s[20:23], s53 offen offset:2048 nt lds
    s_add_u32 m0, s47, 15360
    s_waitcnt vmcnt(39)
    buffer_load_dwordx4 v1, s[20:23], s54 offen offset:0 nt lds
    v_add_u32 v47, 1, v47
    ds_write_b32 v46, v47 offset:0
    s_waitcnt vmcnt(39)
    buffer_load_dwordx4 v1, s[20:23], s54 offen offset:1024 nt lds
    s_waitcnt vmcnt(39)
    buffer_load_dwordx4 v1, s[20:23], s54 offen offset:2048 nt lds
    v_readlane_b32 s56, v26, s52
    v_readlane_b32 s57, v27, s52
    s_add_u32 s52, s52, 1
    s_and_b32 s52, s52, 63
    s_nop 2
    s_add_u32 m0, s47, 18432
    s_waitcnt vmcnt(39)
    buffer_load_dwordx4 v1, s[20:23], s56 offen offset:0 nt lds
    s_waitcnt vmcnt(39)
    buffer_load_dwordx4 v1, s[20:23], s56 offen offset:1024 nt lds
    s_waitcnt vmcnt(39)
    buffer_load_dwordx4 v1, s[20:23], s56 offen offset:2048 nt lds
    s_add_u32 m0, s47, 21504
    s_waitcnt vmcnt(39)
    buffer_load_dwordx4 v1, s[20:23], s57 offen offset:0 nt lds
    v_add_u32 v47, 1, v47
    ds_write_b32 v46, v47 offset:0
    s_waitcnt vmcnt(39)
    buffer_load_dwordx4 v1, s[20:23], s57 offen offset:1024 nt lds
    s_waitcnt vmcnt(39)
    buffer_load_dwordx4 v1, s[20:23], s57 offen offset:2048 nt lds
    s_add_u32 s47, s47, 24576
    s_cmp_eq_u32 s47, 122880
    s_cselect_b32 s47, 0, s47
    v_readlane_b32 s53, v26, s52
    v_readlane_b32 s54, v27, s52
    s_add_u32 s52, s52, 1
    s_and_b32 s52, s52, 63
    s_nop 2
    s_add_u32 m0, s47, 0
    s_waitcnt vmcnt(39)
    buffer_load_dwordx4 v1, s[20:23], s53 offen offset:0 nt lds
    s_waitcnt vmcnt(39)
    buffer_load_dwordx4 v1, s[20:23], s53 offen offset:1024 nt lds
    s_waitcnt vmcnt(39)
    buffer_load_dwordx4 v1, s[20:23], s53 offen offset:2048 nt lds
    s_add_u32 m0, s47, 3072
    s_waitcnt vmcnt(39)
    buffer_load_dwordx4 v1, s[20:23], s54 offen offset:0 nt lds
    v_add_u32 v47, 1, v47
    ds_write_b32 v46, v47 offset:0
    s_waitcnt vmcnt(39)
    buffer_load_dwordx4 v1, s[20:23], s54 offen offset:1024 nt lds
    s_waitcnt vmcnt(39)
    buffer_load_dwordx4 v1, s[20:23], s54 offen offset:2048 nt lds
    v_readlane_b32 s56, v26, s52
    v_readlane_b32 s57, v27, s52
    s_add_u32 s52, s52, 1
    s_and_b32 s52, s52, 63
    s_nop 2
    s_add_u32 m0, s47, 6144
    s_waitcnt vmcnt(39)
    buffer_load_dwordx4 v1, s[20:23], s56 offen offset:0 nt lds
    s_waitcnt vmcnt(39)
    buffer_load_dwordx4 v1, s[20:23], s56 offen offset:1024 nt lds
    s_waitcnt vmcnt(39)
    buffer_load_dwordx4 v1, s[20:23], s56 offen offset:2048 nt lds
    s_add_u32 m0, s47, 9216
    s_waitcnt vmcnt(39)
    buffer_load_dwordx4 v1, s[20:23], s57 offen offset:0 nt lds
    v_add_u32 v47, 1, v47
    ds_write_b32 v46, v47 offset:0
    s_waitcnt vmcnt(39)
    buffer_load_dwordx4 v1, s[20:23], s57 offen offset:1024 nt lds
    s_waitcnt vmcnt(39)
    buffer_load_dwordx4 v1, s[20:23], s57 offen offset:2048 nt lds
    v_readlane_b32 s53, v26, s52
    v_readlane_b32 s54, v27, s52
    s_add_u32 s52, s52, 1
    s_and_b32 s52, s52, 63
    s_nop 2
    s_add_u32 m0, s47, 12288
    s_waitcnt vmcnt(39)
    buffer_load_dwordx4 v1, s[20:23], s53 offen offset:0 nt lds
    s_waitcnt vmcnt(39)
    buffer_load_dwordx4 v1, s[20:23], s53 offen offset:1024 nt lds
    s_waitcnt vmcnt(39)
    buffer_load_dwordx4 v1, s[20:23], s53 offen offset:2048 nt lds
    s_add_u32 m0, s47, 15360
    s_waitcnt vmcnt(39)
    buffer_load_dwordx4 v1, s[20:23], s54 offen offset:0 nt lds
    v_add_u32 v47, 1, v47
    ds_write_b32 v46, v47 offset:0
    s_waitcnt vmcnt(39)
    buffer_load_dwordx4 v1, s[20:23], s54 offen offset:1024 nt lds
    s_waitcnt vmcnt(39)
    buffer_load_dwordx4 v1, s[20:23], s54 offen offset:2048 nt lds
    v_readlane_b32 s56, v26, s52
    v_readlane_b32 s57, v27, s52
    s_add_u32 s52, s52, 1
    s_and_b32 s52, s52, 63
    s_nop 2
    s_add_u32 m0, s47, 18432
    s_waitcnt vmcnt(39)
    buffer_load_dwordx4 v1, s[20:23], s56 offen offset:0 nt lds
    s_waitcnt vmcnt(39)
    buffer_load_dwordx4 v1, s[20:23], s56 offen offset:1024 nt lds
    s_waitcnt vmcnt(39)
    buffer_load_dwordx4 v1, s[20:23], s56 offen offset:2048 nt lds
    s_add_u32 m0, s47, 21504
    s_waitcnt vmcnt(39)
    buffer_load_dwordx4 v1, s[20:23], s57 offen offset:0 nt lds
    v_add_u32 v47, 1, v47
    ds_write_b32 v46, v47 offset:0
    s_waitcnt vmcnt(39)
    buffer_load_dwordx4 v1, s[20:23], s57 offen offset:1024 nt lds
    s_waitcnt vmcnt(39)
    buffer_load_dwordx4 v1, s[20:23], s57 offen offset:2048 nt lds
    s_add_u32 s47, s47, 24576
    s_cmp_eq_u32 s47, 122880
    s_cselect_b32 s47, 0, s47
    v_readlane_b32 s53, v26, s52
    v_readlane_b32 s54, v27, s52
    s_add_u32 s52, s52, 1
    s_and_b32 s52, s52, 63
    s_nop 2
    s_add_u32 m0, s47, 0
    s_waitcnt vmcnt(39)
    buffer_load_dwordx4 v1, s[20:23], s53 offen offset:0 nt lds
    s_waitcnt vmcnt(39)
    buffer_load_dwordx4 v1, s[20:23], s53 offen offset:1024 nt lds
    s_waitcnt vmcnt(39)
    buffer_load_dwordx4 v1, s[20:23], s53 offen offset:2048 nt lds
    s_add_u32 m0, s47, 3072
    s_waitcnt vmcnt(39)
    buffer_load_dwordx4 v1, s[20:23], s54 offen offset:0 nt lds
    v_add_u32 v47, 1, v47
    ds_write_b32 v46, v47 offset:0
    s_waitcnt vmcnt(39)
    buffer_load_dwordx4 v1, s[20:23], s54 offen offset:1024 nt lds
    s_waitcnt vmcnt(39)
    buffer_load_dwordx4 v1, s[20:23], s54 offen offset:2048 nt lds
    v_readlane_b32 s56, v26, s52
    v_readlane_b32 s57, v27, s52
    s_add_u32 s52, s52, 1
    s_and_b32 s52, s52, 63
    s_nop 2
    s_add_u32 m0, s47, 6144
    s_waitcnt vmcnt(39)
    buffer_load_dwordx4 v1, s[20:23], s56 offen offset:0 nt lds
    s_waitcnt vmcnt(39)
    buffer_load_dwordx4 v1, s[20:23], s56 offen offset:1024 nt lds
    s_waitcnt vmcnt(39)
    buffer_load_dwordx4 v1, s[20:23], s56 offen offset:2048 nt lds
    s_add_u32 m0, s47, 9216
    s_waitcnt vmcnt(39)
    buffer_load_dwordx4 v1, s[20:23], s57 offen offset:0 nt lds
    v_add_u32 v47, 1, v47
    ds_write_b32 v46, v47 offset:0
    s_waitcnt vmcnt(39)
    buffer_load_dwordx4 v1, s[20:23], s57 offen offset:1024 nt lds
    s_waitcnt vmcnt(39)
    buffer_load_dwordx4 v1, s[20:23], s57 offen offset:2048 nt lds
    v_readlane_b32 s53, v26, s52
    v_readlane_b32 s54, v27, s52
    s_add_u32 s52, s52, 1
    s_and_b32 s52, s52, 63
    s_nop 2
    s_add_u32 m0, s47, 12288
    s_waitcnt vmcnt(39)
    buffer_load_dwordx4 v1, s[20:23], s53 offen offset:0 nt lds
    s_waitcnt vmcnt(39)
    buffer_load_dwordx4 v1, s[20:23], s53 offen offset:1024 nt lds
    s_waitcnt vmcnt(39)
    buffer_load_dwordx4 v1, s[20:23], s53 offen offset:2048 nt lds
    s_add_u32 m0, s47, 15360
    s_waitcnt vmcnt(39)
    buffer_load_dwordx4 v1, s[20:23], s54 offen offset:0 nt lds
    v_add_u32 v47, 1, v47
    ds_write_b32 v46, v47 offset:0
    s_waitcnt vmcnt(39)
    buffer_load_dwordx4 v1, s[20:23], s54 offen offset:1024 nt lds
    s_waitcnt vmcnt(39)
    buffer_load_dwordx4 v1, s[20:23], s54 offen offset:2048 nt lds
    v_readlane_b32 s56, v26, s52
    v_readlane_b32 s57, v27, s52
    s_add_u32 s52, s52, 1
    s_and_b32 s52, s52, 63
    s_nop 2
    s_add_u32 m0, s47, 18432
    s_waitcnt vmcnt(39)
    buffer_load_dwordx4 v1, s[20:23], s56 offen offset:0 nt lds
    s_waitcnt vmcnt(39)
    buffer_load_dwordx4 v1, s[20:23], s56 offen offset:1024 nt lds
    s_bitcmp1_b32 s2, 7
    s_cbranch_scc0 L_cb2
    s_barrier
    s_barrier
L_cb2:
    s_waitcnt vmcnt(39)
    buffer_load_dwordx4 v1, s[20:23], s56 offen offset:2048 nt lds
    s_add_u32 m0, s47, 21504
    s_waitcnt vmcnt(39)
    buffer_load_dwordx4 v1, s[20:23], s57 offen offset:0 nt lds
    v_add_u32 v47, 1, v47
    ds_write_b32 v46, v47 offset:0
    s_waitcnt vmcnt(39)
    buffer_load_dwordx4 v1, s[20:23], s57 offen offset:1024 nt lds
    s_waitcnt vmcnt(39)
    buffer_load_dwordx4 v1, s[20:23], s57 offen offset:2048 nt lds
    s_add_u32 s47, s47, 24576
    s_cmp_eq_u32 s47, 122880
    s_cselect_b32 s47, 0, s47
    v_readlane_b32 s53, v26, s52
    v_readlane_b32 s54, v27, s52
    s_add_u32 s52, s52, 1
    s_and_b32 s52, s52, 63
    s_nop 2
    s_mov_b32 m0, 122880
    s_mov_b32 s67, 0
    s_waitcnt vmcnt(18)
    buffer_load_dwordx4 v20, s[32:35], s67 offen nt lds
    v_add_u32 v47, 1, v47
    ds_write_b32 v46, v47 offset:0
    s_mov_b32 m0, 123904
    s_mov_b32 s67, 0
    s_waitcnt vmcnt(18)
    buffer_load_dwordx4 v21, s[32:35], s67 offen nt lds
    v_add_u32 v47, 1, v47
    ds_write_b32 v46, v47 offset:0
    s_mov_b32 m0, 124928
    s_mov_b32 s67, 0
    s_waitcnt vmcnt(18)
    buffer_load_dwordx4 v22, s[32:35], s67 offen nt lds
    s_mov_b32 m0, 125952
    s_mov_b32 s67, 0
    s_waitcnt vmcnt(18)
    buffer_load_dwordx4 v23, s[32:35], s67 offen nt lds
    s_mov_b32 m0, 126976
    s_mov_b32 s67, 0
    s_waitcnt vmcnt(18)
    buffer_load_dwordx4 v24, s[32:35], s67 offen nt lds
    s_mov_b32 m0, 128000
    s_mov_b32 s67, 40960
    s_waitcnt vmcnt(18)
    buffer_load_dwordx4 v20, s[32:35], s67 offen nt lds
    s_mov_b32 m0, 129024
    s_mov_b32 s67, 40960
    s_waitcnt vmcnt(18)
    buffer_load_dwordx4 v21, s[32:35], s67 offen nt lds
    s_mov_b32 m0, 130048
    s_mov_b32 s67, 40960
    s_waitcnt vmcnt(18)
    buffer_load_dwordx4 v22, s[32:35], s67 offen nt lds
    s_mov_b32 m0, 131072
    s_mov_b32 s67, 40960
    s_waitcnt vmcnt(18)
    buffer_load_dwordx4 v23, s[32:35], s67 offen nt lds
    s_mov_b32 m0, 132096
    s_mov_b32 s67, 40960
    s_waitcnt vmcnt(18)
    buffer_load_dwordx4 v24, s[32:35], s67 offen nt lds
    s_mov_b32 m0, 133120
    s_mov_b32 s67, 81920
    s_waitcnt vmcnt(18)
    buffer_load_dwordx4 v20, s[32:35], s67 offen nt lds
    s_mov_b32 m0, 134144
    s_mov_b32 s67, 81920
    s_waitcnt vmcnt(18)
    buffer_load_dwordx4 v21, s[32:35], s67 offen nt lds
    s_mov_b32 m0, 135168
    s_mov_b32 s67, 81920
    s_waitcnt vmcnt(18)
    buffer_load_dwordx4 v22, s[32:35], s67 offen nt lds
    s_mov_b32 m0, 136192
    s_mov_b32 s67, 81920
    s_waitcnt vmcnt(18)
    buffer_load_dwordx4 v23, s[32:35], s67 offen nt lds
    s_mov_b32 m0, 137216
    s_mov_b32 s67, 81920
    s_waitcnt vmcnt(18)
    buffer_load_dwordx4 v24, s[32:35], s67 offen nt lds
    s_mov_b32 m0, 138240
    s_mov_b32 s67, 122880
    s_waitcnt vmcnt(18)
    buffer_load_dwordx4 v20, s[32:35], s67 offen nt lds
    s_mov_b32 m0, 139264
    s_mov_b32 s67, 122880
    s_waitcnt vmcnt(18)
    buffer_load_dwordx4 v21, s[32:35], s67 offen nt lds
    s_mov_b32 m0, 140288
    s_mov_b32 s67, 122880
    s_waitcnt vmcnt(18)
    buffer_load_dwordx4 v22, s[32:35], s67 offen nt lds
    s_mov_b32 m0, 141312
    s_mov_b32 s67, 122880
    s_waitcnt vmcnt(18)
    buffer_load_dwordx4 v23, s[32:35], s67 offen nt lds
    s_mov_b32 m0, 142336
    s_mov_b32 s67, 122880
    s_waitcnt vmcnt(18)
    buffer_load_dwordx4 v24, s[32:35], s67 offen nt lds
    s_setprio 3
    s_mov_b32 s43, 5
    ds_read_b128 v[12:15], v46 offset:16
    s_waitcnt lgkmcnt(0)
    v_min3_u32 v16, v12, v13, v14
    v_min_u32 v16, v16, v15
    v_readfirstlane_b32 s67, v17
    v_readfirstlane_b32 s65, v16
.p2align 6
L_load:
    s_add_u32 s66, s65, 4
    s_cmp_ge_u32 s66, s43
    s_cbranch_scc0 L_wait
L_go:
    s_cmp_eq_u32 s67, 1
    s_cbranch_scc1 L_lv1
    s_cmp_eq_u32 s67, 2
    s_cbranch_scc1 L_lv2
    s_cmp_eq_u32 s67, 3
    s_cbranch_scc1 L_lv3
    s_add_u32 m0, s47, 0
    s_waitcnt vmcnt(17)
    buffer_load_dwordx4 v1, s[20:23], s53 offen offset:0 nt lds
    s_waitcnt vmcnt(17)
    buffer_load_dwordx4 v1, s[20:23], s53 offen offset:1024 nt lds
    s_waitcnt vmcnt(17)
    buffer_load_dwordx4 v1, s[20:23], s53 offen offset:2048 nt lds
    v_readlane_b32 s56, v26, s52
    v_readlane_b32 s57, v27, s52
    s_add_u32 s52, s52, 1
    s_and_b32 s52, s52, 63
    s_add_u32 m0, s47, 3072
    s_waitcnt vmcnt(17)
    buffer_load_dwordx4 v1, s[20:23], s54 offen offset:0 nt lds
    s_waitcnt vmcnt(17)
    buffer_load_dwordx4 v1, s[20:23], s54 offen offset:1024 nt lds
    s_waitcnt vmcnt(17)
    buffer_load_dwordx4 v1, s[20:23], s54 offen offset:2048 nt lds
    s_add_u32 m0, s47, 6144
    s_waitcnt vmcnt(17)
    buffer_load_dwordx4 v1, s[20:23], s56 offen offset:0 nt lds
    v_add_u32 v47, 2, v47
    ds_write_b32 v46, v47 offset:0
    s_waitcnt vmcnt(17)
    buffer_load_dwordx4 v1, s[20:23], s56 offen offset:1024 nt lds
    s_waitcnt vmcnt(17)
    buffer_load_dwordx4 v1, s[20:23], s56 offen offset:2048 nt lds
    v_readlane_b32 s53, v26, s52
    v_readlane_b32 s54, v27, s52
    s_add_u32 s52, s52, 1
    s_and_b32 s52, s52, 63
    s_add_u32 m0, s47, 9216
    s_waitcnt vmcnt(17)
    buffer_load_dwordx4 v1, s[20:23], s57 offen offset:0 nt lds
    s_waitcnt vmcnt(17)
    buffer_load_dwordx4 v1, s[20:23], s57 offen offset:1024 nt lds
    s_waitcnt vmcnt(17)
    buffer_load_dwordx4 v1, s[20:23], s57 offen offset:2048 nt lds
    s_add_u32 m0, s47, 12288
    s_waitcnt vmcnt(17)
    buffer_load_dwordx4 v1, s[20:23], s53 offen offset:0 nt lds
    s_waitcnt vmcnt(17)
    buffer_load_dwordx4 v1, s[20:23], s53 offen offset:1024 nt lds
    s_waitcnt vmcnt(17)
    buffer_load_dwordx4 v1, s[20:23], s53 offen offset:2048 nt lds
    v_readlane_b32 s56, v26, s52
    v_readlane_b32 s57, v27, s52
    s_add_u32 s52, s52, 1
    s_and_b32 s52, s52, 63
    s_add_u32 m0, s47, 15360
    s_waitcnt vmcnt(17)
    buffer_load_dwordx4 v1, s[20:23], s54 offen offset:0 nt lds
    s_waitcnt vmcnt(17)
    buffer_load_dwordx4 v1, s[20:23], s54 offen offset:1024 nt lds
    ds_read_b128 v[12:15], v46 offset:16
    ds_read_b32 v17, v46 offset:8
    s_waitcnt vmcnt(17)
    buffer_load_dwordx4 v1, s[20:23], s54 offen offset:2048 nt lds
    s_add_u32 s62, s43, 1
    s_and_b32 s63, s62, 31
    s_add_u32 m0, s47, 18432
    s_waitcnt vmcnt(17)
    buffer_load_dwordx4 v1, s[20:23], s56 offen offset:0 nt lds
    v_add_u32 v47, 2, v47
    ds_write_b32 v46, v47 offset:0
    s_cmp_eq_u32 s63, 0
    s_cbranch_scc1 L_tbl0
L_tbl0_ret:
    s_waitcnt vmcnt(17)
    buffer_load_dwordx4 v1, s[20:23], s56 offen offset:1024 nt lds
    s_waitcnt vmcnt(17)
    buffer_load_dwordx4 v1, s[20:23], s56 offen offset:2048 nt lds
    s_add_u32 m0, s47, 21504
    s_waitcnt vmcnt(17)
    buffer_load_dwordx4 v1, s[20:23], s57 offen offset:0 nt lds
    v_readlane_b32 s53, v26, s52
    v_readlane_b32 s54, v27, s52
    s_add_u32 s52, s52, 1
    s_and_b32 s52, s52, 63
    s_waitcnt vmcnt(17)
    buffer_load_dwordx4 v1, s[20:23], s57 offen offset:1024 nt lds
    s_waitcnt lgkmcnt(0)
    v_min3_u32 v16, v12, v13, v14
    v_min_u32 v16, v16, v15
    v_readfirstlane_b32 s67, v17
    v_readfirstlane_b32 s65, v16
    s_waitcnt vmcnt(17)
    buffer_load_dwordx4 v1, s[20:23], s57 offen offset:2048 nt lds
    s_branch L_join
L_lv1:
    s_add_u32 m0, s47, 0
    s_waitcnt vmcnt(18)
    buffer_load_dwordx4 v1, s[20:23], s53 offen offset:0 nt lds
    s_waitcnt vmcnt(18)
    buffer_load_dwordx4 v1, s[20:23], s53 offen offset:1024 nt lds
    s_waitcnt vmcnt(18)
    buffer_load_dwordx4 v1, s[20:23], s53 offen offset:2048 nt lds
    v_readlane_b32 s56, v26, s52
    v_readlane_b32 s57, v27, s52
    s_add_u32 s52, s52, 1
    s_and_b32 s52, s52, 63
    s_add_u32 m0, s47, 3072
    s_waitcnt vmcnt(18)
    buffer_load_dwordx4 v1, s[20:23], s54 offen offset:0 nt lds
    s_waitcnt vmcnt(18)
    buffer_load_dwordx4 v1, s[20:23], s54 offen offset:1024 nt lds
    s_waitcnt vmcnt(18)
    buffer_load_dwordx4 v1, s[20:23], s54 offen offset:2048 nt lds
    s_add_u32 m0, s47, 6144
    s_waitcnt vmcnt(18)
    buffer_load_dwordx4 v1, s[20:23], s56 offen offset:0 nt lds
    v_add_u32 v47, 2, v47
    ds_write_b32 v46, v47 offset:0
    s_waitcnt vmcnt(18)
    buffer_load_dwordx4 v1, s[20:23], s56 offen offset:1024 nt lds
    s_waitcnt vmcnt(18)
    buffer_load_dwordx4 v1, s[20:23], s56 offen offset:2048 nt lds
    v_readlane_b32 s53, v26, s52
    v_readlane_b32 s54, v27, s52
    s_add_u32 s52, s52, 1
    s_and_b32 s52, s52, 63
    s_add_u32 m0, s47, 9216
    s_waitcnt vmcnt(18)
    buffer_load_dwordx4 v1, s[20:23], s57 offen offset:0 nt lds
    s_waitcnt vmcnt(18)
    buffer_load_dwordx4 v1, s[20:23], s57 offen offset:1024 nt lds
    s_waitcnt vmcnt(18)
    buffer_load_dwordx4 v1, s[20:23], s57 offen offset:2048 nt lds
    s_add_u32 m0, s47, 12288
    s_waitcnt vmcnt(18)
    buffer_load_dwordx4 v1, s[20:23], s53 offen offset:0 nt lds
    s_waitcnt vmcnt(18)
    buffer_load_dwordx4 v1, s[20:23], s53 offen offset:1024 nt lds
    s_waitcnt vmcnt(18)
    buffer_load_dwordx4 v1, s[20:23], s53 offen offset:2048 nt lds
    v_readlane_b32 s56, v26, s52
    v_readlane_b32 s57, v27, s52
    s_add_u32 s52, s52, 1
    s_and_b32 s52, s52, 63
    s_add_u32 m0, s47, 15360
    s_waitcnt vmcnt(18)
    buffer_load_dwordx4 v1, s[20:23], s54 offen offset:0 nt lds
    s_waitcnt vmcnt(18)
    buffer_load_dwordx4 v1, s[20:23], s54 offen offset:1024 nt lds
    ds_read_b128 v[12:15], v46 offset:16
    ds_read_b32 v17, v46 offset:8
    s_waitcnt vmcnt(18)
    buffer_load_dwordx4 v1, s[20:23], s54 offen offset:2048 nt lds
    s_add_u32 s62, s43, 1
    s_and_b32 s63, s62, 31
    s_add_u32 m0, s47, 18432
    s_waitcnt vmcnt(18)
    buffer_load_dwordx4 v1, s[20:23], s56 offen offset:0 nt lds
    v_add_u32 v47, 2, v47
    ds_write_b32 v46, v47 offset:0
    s_cmp_eq_u32 s63, 0
    s_cbranch_scc1 L_tbl1
L_tbl1_ret:
    s_waitcnt vmcnt(18)
    buffer_load_dwordx4 v1, s[20:23], s56 offen offset:1024 nt lds
    s_waitcnt vmcnt(18)
    buffer_load_dwordx4 v1, s[20:23], s56 offen offset:2048 nt lds
    s_add_u32 m0, s47, 21504
    s_waitcnt vmcnt(18)
    buffer_load_dwordx4 v1, s[20:23], s57 offen offset:0 nt lds
    v_readlane_b32 s53, v26, s52
    v_readlane_b32 s54, v27, s52
    s_add_u32 s52, s52, 1
    s_and_b32 s52, s52, 63
    s_waitcnt vmcnt(18)
    buffer_load_dwordx4 v1, s[20:23], s57 offen offset:1024 nt lds
    s_waitcnt lgkmcnt(0)
    v_min3_u32 v16, v12, v13, v14
    v_min_u32 v16, v16, v15
    v_readfirstlane_b32 s67, v17
    v_readfirstlane_b32 s65, v16
    s_waitcnt vmcnt(18)
    buffer_load_dwordx4 v1, s[20:23], s57 offen offset:2048 nt lds
    s_branch L_join
L_lv2:
    s_add_u32 m0, s47, 0
    s_waitcnt vmcnt(19)
    buffer_load_dwordx4 v1, s[20:23], s53 offen offset:0 nt lds
    s_waitcnt vmcnt(19)
    buffer_load_dwordx4 v1, s[20:23], s53 offen offset:1024 nt lds
    s_waitcnt vmcnt(19)
    buffer_load_dwordx4 v1, s[20:23], s53 offen offset:2048 nt lds
    v_readlane_b32 s56, v26, s52
    v_readlane_b32 s57, v27, s52
    s_add_u32 s52, s52, 1
    s_and_b32 s52, s52, 63
    s_add_u32 m0, s47, 3072
    s_waitcnt vmcnt(19)
    buffer_load_dwordx4 v1, s[20:23], s54 offen offset:0 nt lds
    s_waitcnt vmcnt(19)
    buffer_load_dwordx4 v1, s[20:23], s54 offen offset:1024 nt lds
    s_waitcnt vmcnt(19)
    buffer_load_dwordx4 v1, s[20:23], s54 offen offset:2048 nt lds
    s_add_u32 m0, s47, 6144
    s_waitcnt vmcnt(19)
    buffer_load_dwordx4 v1, s[20:23], s56 offen offset:0 nt lds
    v_add_u32 v47, 2, v47
    ds_write_b32 v46, v47 offset:0
    s_waitcnt vmcnt(19)
    buffer_load_dwordx4 v1, s[20:23], s56 offen offset:1024 nt lds
    s_waitcnt vmcnt(19)
    buffer_load_dwordx4 v1, s[20:23], s56 offen offset:2048 nt lds
    v_readlane_b32 s53, v26, s52
    v_readlane_b32 s54, v27, s52
    s_add_u32 s52, s52, 1
    s_and_b32 s52, s52, 63
    s_add_u32 m0, s47, 9216
    s_waitcnt vmcnt(19)
    buffer_load_dwordx4 v1, s[20:23], s57 offen offset:0 nt lds
    s_waitcnt vmcnt(19)
    buffer_load_dwordx4 v1, s[20:23], s57 offen offset:1024 nt lds
    s_waitcnt vmcnt(19)
    buffer_load_dwordx4 v1, s[20:23], s57 offen offset:2048 nt lds
    s_add_u32 m0, s47, 12288
    s_waitcnt vmcnt(19)
    buffer_load_dwordx4 v1, s[20:23], s53 offen offset:0 nt lds
    s_waitcnt vmcnt(19)
    buffer_load_dwordx4 v1, s[20:23], s53 offen offset:1024 nt lds
    s_waitcnt vmcnt(19)
    buffer_load_dwordx4 v1, s[20:23], s53 offen offset:2048 nt lds
    v_readlane_b32 s56, v26, s52
    v_readlane_b32 s57, v27, s52
    s_add_u32 s52, s52, 1
    s_and_b32 s52, s52, 63
    s_add_u32 m0, s47, 15360
    s_waitcnt vmcnt(19)
    buffer_load_dwordx4 v1, s[20:23], s54 offen offset:0 nt lds
    s_waitcnt vmcnt(19)
    buffer_load_dwordx4 v1, s[20:23], s54 offen offset:1024 nt lds
    ds_read_b128 v[12:15], v46 offset:16
    ds_read_b32 v17, v46 offset:8
    s_waitcnt vmcnt(19)
    buffer_load_dwordx4 v1, s[20:23], s54 offen offset:2048 nt lds
    s_add_u32 s62, s43, 1
    s_and_b32 s63, s62, 31
    s_add_u32 m0, s47, 18432
    s_waitcnt vmcnt(19)
    buffer_load_dwordx4 v1, s[20:23], s56 offen offset:0 nt lds
    v_add_u32 v47, 2, v47
    ds_write_b32 v46, v47 offset:0
    s_cmp_eq_u32 s63, 0
    s_cbranch_scc1 L_tbl2
L_tbl2_ret:
    s_waitcnt vmcnt(19)
    buffer_load_dwordx4 v1, s[20:23], s56 offen offset:1024 nt lds
    s_waitcnt vmcnt(19)
    buffer_load_dwordx4 v1, s[20:23], s56 offen offset:2048 nt lds
    s_add_u32 m0, s47, 21504
    s_waitcnt vmcnt(19)
    buffer_load_dwordx4 v1, s[20:23], s57 offen offset:0 nt lds
    v_readlane_b32 s53, v26, s52
    v_readlane_b32 s54, v27, s52
    s_add_u32 s52, s52, 1
    s_and_b32 s52, s52, 63
    s_waitcnt vmcnt(19)
    buffer_load_dwordx4 v1, s[20:23], s57 offen offset:1024 nt lds
    s_waitcnt lgkmcnt(0)
    v_min3_u32 v16, v12, v13, v14
    v_min_u32 v16, v16, v15
    v_readfirstlane_b32 s67, v17
    v_readfirstlane_b32 s65, v16
    s_waitcnt vmcnt(19)
    buffer_load_dwordx4 v1, s[20:23], s57 offen offset:2048 nt lds
    s_branch L_join
L_lv3:
    s_add_u32 m0, s47, 0
    s_waitcnt vmcnt(24)
    buffer_load_dwordx4 v1, s[20:23], s53 offen offset:0 nt lds
    s_waitcnt vmcnt(24)
    buffer_load_dwordx4 v1, s[20:23], s53 offen offset:1024 nt lds
    s_waitcnt vmcnt(24)
    buffer_load_dwordx4 v1, s[20:23], s53 offen offset:2048 nt lds
    v_readlane_b32 s56, v26, s52
    v_readlane_b32 s57, v27, s52
    s_add_u32 s52, s52, 1
    s_and_b32 s52, s52, 63
    s_add_u32 m0, s47, 3072
    s_waitcnt vmcnt(24)
    buffer_load_dwordx4 v1, s[20:23], s54 offen offset:0 nt lds
    s_waitcnt vmcnt(24)
    buffer_load_dwordx4 v1, s[20:23], s54 offen offset:1024 nt lds
    s_waitcnt vmcnt(24)
    buffer_load_dwordx4 v1, s[20:23], s54 offen offset:2048 nt lds
    s_add_u32 m0, s47, 6144
    s_waitcnt vmcnt(24)
    buffer_load_dwordx4 v1, s[20:23], s56 offen offset:0 nt lds
    v_add_u32 v47, 2, v47
    ds_write_b32 v46, v47 offset:0
    s_waitcnt vmcnt(24)
    buffer_load_dwordx4 v1, s[20:23], s56 offen offset:1024 nt lds
    s_waitcnt vmcnt(24)
    buffer_load_dwordx4 v1, s[20:23], s56 offen offset:2048 nt lds
    v_readlane_b32 s53, v26, s52
    v_readlane_b32 s54, v27, s52
    s_add_u32 s52, s52, 1
    s_and_b32 s52, s52, 63
    s_add_u32 m0, s47, 9216
    s_waitcnt vmcnt(24)
    buffer_load_dwordx4 v1, s[20:23], s57 offen offset:0 nt lds
    s_waitcnt vmcnt(24)
    buffer_load_dwordx4 v1, s[20:23], s57 offen offset:1024 nt lds
    s_waitcnt vmcnt(24)
    buffer_load_dwordx4 v1, s[20:23], s57 offen offset:2048 nt lds
    s_add_u32 m0, s47, 12288
    s_waitcnt vmcnt(24)
    buffer_load_dwordx4 v1, s[20:23], s53 offen offset:0 nt lds
    s_waitcnt vmcnt(24)
    buffer_load_dwordx4 v1, s[20:23], s53 offen offset:1024 nt lds
    s_waitcnt vmcnt(24)
    buffer_load_dwordx4 v1, s[20:23], s53 offen offset:2048 nt lds
    v_readlane_b32 s56, v26, s52
    v_readlane_b32 s57, v27, s52
    s_add_u32 s52, s52, 1
    s_and_b32 s52, s52, 63
    s_add_u32 m0, s47, 15360
    s_waitcnt vmcnt(24)
    buffer_load_dwordx4 v1, s[20:23], s54 offen offset:0 nt lds
    s_waitcnt vmcnt(24)
    buffer_load_dwordx4 v1, s[20:23], s54 offen offset:1024 nt lds
    ds_read_b128 v[12:15], v46 offset:16
    ds_read_b32 v17, v46 offset:8
    s_waitcnt vmcnt(24)
    buffer_load_dwordx4 v1, s[20:23], s54 offen offset:2048 nt lds
    s_add_u32 s62, s43, 1
    s_and_b32 s63, s62, 31
    s_add_u32 m0, s47, 18432
    s_waitcnt vmcnt(24)
    buffer_load_dwordx4 v1, s[20:23], s56 offen offset:0 nt lds
    v_add_u32 v47, 2, v47
    ds_write_b32 v46, v47 offset:0
    s_cmp_eq_u32 s63, 0
    s_cbranch_scc1 L_tbl3
L_tbl3_ret:
    s_waitcnt vmcnt(24)
    buffer_load_dwordx4 v1, s[20:23], s56 offen offset:1024 nt lds
    s_waitcnt vmcnt(24)
    buffer_load_dwordx4 v1, s[20:23], s56 offen offset:2048 nt lds
    s_add_u32 m0, s47, 21504
    s_waitcnt vmcnt(24)
    buffer_load_dwordx4 v1, s[20:23], s57 offen offset:0 nt lds
    v_readlane_b32 s53, v26, s52
    v_readlane_b32 s54, v27, s52
    s_add_u32 s52, s52, 1
    s_and_b32 s52, s52, 63
    s_waitcnt vmcnt(24)
    buffer_load_dwordx4 v1, s[20:23], s57 offen offset:1024 nt lds
    s_waitcnt lgkmcnt(0)
    v_min3_u32 v16, v12, v13, v14
    v_min_u32 v16, v16, v15
    v_readfirstlane_b32 s67, v17
    v_readfirstlane_b32 s65, v16
    s_waitcnt vmcnt(24)
    buffer_load_dwordx4 v1, s[20:23], s57 offen offset:2048 nt lds
L_join:
    s_add_u32 s47, s47, 24576
    s_cmp_eq_u32 s47, 122880
    s_cselect_b32 s47, 0, s47
    s_mov_b32 s43, s62
    s_bitcmp1_b32 s43, 4
    s_cselect_b32 s20, s26, s24
    s_cselect_b32 s21, s27, s25
    s_cmp_lt_u32 s43, 127
    s_cbranch_scc1 L_load
L_fin0:
    s_waitcnt lgkmcnt(0)
    v_min3_u32 v16, v12, v13, v14
    v_min_u32 v16, v16, v15
    s_add_u32 s48, s48, 1
    v_readfirstlane_b32 s65, v16
    ds_read_b128 v[12:15], v46 offset:16
    s_cmp_gt_u32 s48, 16777216
    s_cselect_b32 s65, 128, s65
    s_cmp_lt_u32 s65, 123
    s_cbranch_scc1 L_fin0
    s_add_u32 m0, s47, 0
    s_waitcnt vmcnt(39)
    buffer_load_dwordx4 v1, s[20:23], s53 offen offset:0 nt lds
    s_waitcnt vmcnt(39)
    buffer_load_dwordx4 v1, s[20:23], s53 offen offset:1024 nt lds
    s_waitcnt vmcnt(39)
    buffer_load_dwordx4 v1, s[20:23], s53 offen offset:2048 nt lds
    s_add_u32 m0, s47, 3072
    s_waitcnt vmcnt(39)
    buffer_load_dwordx4 v1, s[20:23], s54 offen offset:0 nt lds
    s_waitcnt vmcnt(39)
    buffer_load_dwordx4 v1, s[20:23], s54 offen offset:1024 nt lds
    s_waitcnt vmcnt(39)
    buffer_load_dwordx4 v1, s[20:23], s54 offen offset:2048 nt lds
    v_readlane_b32 s56, v26, s52
    v_readlane_b32 s57, v27, s52
    s_add_u32 s52, s52, 1
    s_and_b32 s52, s52, 63
    s_nop 2
    s_add_u32 m0, s47, 6144
    s_waitcnt vmcnt(39)
    buffer_load_dwordx4 v1, s[20:23], s56 offen offset:0 nt lds
    s_waitcnt vmcnt(39)
    buffer_load_dwordx4 v1, s[20:23], s56 offen offset:1024 nt lds
    s_waitcnt vmcnt(39)
    buffer_load_dwordx4 v1, s[20:23], s56 offen offset:2048 nt lds
    s_add_u32 m0, s47, 9216
    s_waitcnt vmcnt(39)
    buffer_load_dwordx4 v1, s[20:23], s57 offen offset:0 nt lds
    s_waitcnt vmcnt(39)
    buffer_load_dwordx4 v1, s[20:23], s57 offen offset:1024 nt lds
    s_waitcnt vmcnt(39)
    buffer_load_dwordx4 v1, s[20:23], s57 offen offset:2048 nt lds
    v_readlane_b32 s53, v26, s52
    v_readlane_b32 s54, v27, s52
    s_add_u32 s52, s52, 1
    s_and_b32 s52, s52, 63
    s_nop 2
    s_add_u32 m0, s47, 12288
    s_waitcnt vmcnt(39)
    buffer_load_dwordx4 v1, s[20:23], s53 offen offset:0 nt lds
    s_waitcnt vmcnt(39)
    buffer_load_dwordx4 v1, s[20:23], s53 offen offset:1024 nt lds
    s_waitcnt vmcnt(39)
    buffer_load_dwordx4 v1, s[20:23], s53 offen offset:2048 nt lds
    s_add_u32 m0, s47, 15360
    s_waitcnt vmcnt(39)
    buffer_load_dwordx4 v1, s[20:23], s54 offen offset:0 nt lds
    v_add_u32 v47, 1, v47
    ds_write_b32 v46, v47 offset:0
    s_waitcnt vmcnt(39)
    buffer_load_dwordx4 v1, s[20:23], s54 offen offset:1024 nt lds
    s_waitcnt vmcnt(39)
    buffer_load_dwordx4 v1, s[20:23], s54 offen offset:2048 nt lds
    v_readlane_b32 s56, v26, s52
    v_readlane_b32 s57, v27, s52
    s_add_u32 s52, s52, 1
    s_and_b32 s52, s52, 63
    s_nop 2
    s_add_u32 m0, s47, 18432
    s_waitcnt vmcnt(39)
    buffer_load_dwordx4 v1, s[20:23], s56 offen offset:0 nt lds
    s_waitcnt vmcnt(39)
    buffer_load_dwordx4 v1, s[20:23], s56 offen offset:1024 nt lds
    s_waitcnt vmcnt(39)
    buffer_load_dwordx4 v1, s[20:23], s56 offen offset:2048 nt lds
    s_add_u32 m0, s47, 21504
    s_waitcnt vmcnt(39)
    buffer_load_dwordx4 v1, s[20:23], s57 offen offset:0 nt lds
    v_add_u32 v47, 1, v47
    ds_write_b32 v46, v47 offset:0
    s_waitcnt vmcnt(39)
    buffer_load_dwordx4 v1, s[20:23], s57 offen offset:1024 nt lds
    s_waitcnt vmcnt(39)
    buffer_load_dwordx4 v1, s[20:23], s57 offen offset:2048 nt lds
    s_mov_b32 m0, 143360
    s_mov_b32 s67, 163840
    s_waitcnt vmcnt(39)
    buffer_load_dwordx4 v20, s[32:35], s67 offen nt lds
    s_mov_b32 m0, 144384
    s_mov_b32 s67, 163840
    s_waitcnt vmcnt(39)
    buffer_load_dwordx4 v21, s[32:35], s67 offen nt lds
    s_mov_b32 m0, 145408
    s_mov_b32 s67, 163840
    s_waitcnt vmcnt(39)
    buffer_load_dwordx4 v22, s[32:35], s67 offen nt lds
    s_mov_b32 m0, 146432
    s_mov_b32 s67, 163840
    s_waitcnt vmcnt(39)
    buffer_load_dwordx4 v23, s[32:35], s67 offen nt lds
    v_add_u32 v47, 1, v47
    ds_write_b32 v46, v47 offset:0
    s_mov_b32 m0, 147456
    s_mov_b32 s67, 163840
    s_waitcnt vmcnt(39)
    buffer_load_dwordx4 v24, s[32:35], s67 offen nt lds
    s_mov_b32 m0, 148480
    s_mov_b32 s67, 204800
    s_waitcnt vmcnt(39)
    buffer_load_dwordx4 v20, s[32:35], s67 offen nt lds
    s_mov_b32 m0, 149504
    s_mov_b32 s67, 204800
    s_waitcnt vmcnt(39)
    buffer_load_dwordx4 v21, s[32:35], s67 offen nt lds
    s_mov_b32 m0, 150528
    s_mov_b32 s67, 204800
    s_waitcnt vmcnt(39)
    buffer_load_dwordx4 v22, s[32:35], s67 offen nt lds
    s_mov_b32 m0, 151552
    s_mov_b32 s67, 204800
    s_waitcnt vmcnt(39)
    buffer_load_dwordx4 v23, s[32:35], s67 offen nt lds
    s_mov_b32 m0, 152576
    s_mov_b32 s67, 204800
    s_waitcnt vmcnt(39)
    buffer_load_dwordx4 v24, s[32:35], s67 offen nt lds
    v_add_u32 v47, 1, v47
    ds_write_b32 v46, v47 offset:0
    s_waitcnt vmcnt(34)
    v_add_u32 v47, 1, v47
    ds_write_b32 v46, v47 offset:0
    s_waitcnt vmcnt(28)
    v_add_u32 v47, 1, v47
    ds_write_b32 v46, v47 offset:0
    s_waitcnt vmcnt(22)
    v_add_u32 v47, 1, v47
    ds_write_b32 v46, v47 offset:0
    s_waitcnt vmcnt(16)
    v_add_u32 v47, 1, v47
    ds_write_b32 v46, v47 offset:0
    s_waitcnt vmcnt(10)
    v_add_u32 v47, 1, v47
    ds_write_b32 v46, v47 offset:0
    s_branch L_tail
L_tbl0:
    v_add_u32 v28, s50, v0
    v_and_b32 v28, 255, v28
    v_and_b32 v29, 63, v28
    v_lshlrev_b32 v28, 1, v28
    v_sub_u32 v28, v28, v29
    v_cmp_le_u32 s[74:75], 21, v29
    v_cmp_le_u32 vcc, 43, v29
    v_add_u32 v26, 21, v28
    v_add_u32 v30, 64, v28
    v_add_u32 v31, 43, v28
    v_cndmask_b32 v26, v26, v30, vcc
    v_cndmask_b32 v27, v28, v31, s[74:75]
    v_mul_u32_u24 v26, 3072, v26
    v_mul_u32_u24 v27, 3072, v27
    s_add_u32 s50, s50, 64
    s_branch L_tbl0_ret
L_tbl1:
    v_add_u32 v28, s50, v0
    v_and_b32 v28, 255, v28
    v_and_b32 v29, 63, v28
    v_lshlrev_b32 v28, 1, v28
    v_sub_u32 v28, v28, v29
    v_cmp_le_u32 s[74:75], 21, v29
    v_cmp_le_u32 vcc, 43, v29
    v_add_u32 v26, 21, v28
    v_add_u32 v30, 64, v28
    v_add_u32 v31, 43, v28
    v_cndmask_b32 v26, v26, v30, vcc
    v_cndmask_b32 v27, v28, v31, s[74:75]
    v_mul_u32_u24 v26, 3072, v26
    v_mul_u32_u24 v27, 3072, v27
    s_add_u32 s50, s50, 64
    s_branch L_tbl1_ret
L_tbl2:
    v_add_u32 v28, s50, v0
    v_and_b32 v28, 255, v28
    v_and_b32 v29, 63, v28
    v_lshlrev_b32 v28, 1, v28
    v_sub_u32 v28, v28, v29
    v_cmp_le_u32 s[74:75], 21, v29
    v_cmp_le_u32 vcc, 43, v29
    v_add_u32 v26, 21, v28
    v_add_u32 v30, 64, v28
    v_add_u32 v31, 43, v28
    v_cndmask_b32 v26, v26, v30, vcc
    v_cndmask_b32 v27, v28, v31, s[74:75]
    v_mul_u32_u24 v26, 3072, v26
    v_mul_u32_u24 v27, 3072, v27
    s_add_u32 s50, s50, 64
    s_branch L_tbl2_ret
L_tbl3:
    v_add_u32 v28, s50, v0
    v_and_b32 v28, 255, v28
    v_and_b32 v29, 63, v28
    v_lshlrev_b32 v28, 1, v28
    v_sub_u32 v28, v28, v29
    v_cmp_le_u32 s[74:75], 21, v29
    v_cmp_le_u32 vcc, 43, v29
    v_add_u32 v26, 21, v28
    v_add_u32 v30, 64, v28
    v_add_u32 v31, 43, v28
    v_cndmask_b32 v26, v26, v30, vcc
    v_cndmask_b32 v27, v28, v31, s[74:75]
    v_mul_u32_u24 v26, 3072, v26
    v_mul_u32_u24 v27, 3072, v27
    s_add_u32 s50, s50, 64
    s_branch L_tbl3_ret
L_wait:
    s_add_u32 s48, s48, 1
    s_cmp_gt_u32 s48, 16777216
    s_cbranch_scc1 L_go
    ds_read_b128 v[12:15], v46 offset:16
    s_waitcnt lgkmcnt(0)
    v_min3_u32 v16, v12, v13, v14
    v_min_u32 v16, v16, v15
    v_readfirstlane_b32 s67, v17
    v_readfirstlane_b32 s65, v16
    s_branch L_load
.p2align 6
L_init:
    v_mov_b32 v24, -1
    v_mov_b32 v25, -1
    v_mov_b32 v26, -1
    v_mov_b32 v27, -1
    v_lshlrev_b32 v56, 4, v0
    s_lshl_b32 s74, s2, 2
    s_add_u32 s74, s74, s3
    s_mul_i32 s74, s74, 5952
    buffer_store_dwordx4 v[24:27], v56, s[28:31], s74 offen offset:0 sc0 sc1
    buffer_store_dwordx4 v[24:27], v56, s[28:31], s74 offen offset:1024 sc0 sc1
    buffer_store_dwordx4 v[24:27], v56, s[28:31], s74 offen offset:2048 sc0 sc1
    buffer_store_dwordx4 v[24:27], v56, s[28:31], s74 offen offset:3072 sc0 sc1
    s_add_u32 s74, s74, 4096
    buffer_store_dwordx4 v[24:27], v56, s[28:31], s74 offen offset:0 sc0 sc1
    s_mov_b32 exec_lo, 0xffffffff
    s_mov_b32 exec_hi, 0xfffff
    buffer_store_dwordx4 v[24:27], v56, s[28:31], s74 offen offset:1024 sc0 sc1
    s_mov_b64 exec, -1
    s_branch L_noinit
L_rest:
    s_bitcmp1_b32 s2, 7
    s_cbranch_scc0 L_cb3
    s_barrier
L_cb3:
    s_add_u32 s72, s72, 12288
    buffer_load_dwordx4 v[100:103], v60, s[32:35], s72 offen
    buffer_load_dwordx4 v[104:107], v61, s[32:35], s72 offen
    buffer_load_dwordx4 v[108:111], v62, s[32:35], s72 offen
    s_lshl_b32 s73, s62, 7
    s_add_u32 s73, s73, s79
    s_mul_i32 s72, s62, 786432
    buffer_load_dword v38, v63, s[36:39], s73 offen
    s_add_u32 s62, s62, 1
    s_cmp_eq_u32 s62, 10
    s_cselect_b32 s62, 0, s62
    buffer_load_dwordx4 v[112:115], v60, s[32:35], s72 offen
    buffer_load_dwordx4 v[116:119], v61, s[32:35], s72 offen
    buffer_load_dwordx4 v[120:123], v62, s[32:35], s72 offen
    s_add_u32 s72, s72, 12288
    buffer_load_dwordx4 v[124:127], v60, s[32:35], s72 offen
    buffer_load_dwordx4 v[128:131], v61, s[32:35], s72 offen
    buffer_load_dwordx4 v[132:135], v62, s[32:35], s72 offen
    s_lshl_b32 s73, s62, 7
    s_add_u32 s73, s73, s79
    s_mul_i32 s72, s62, 786432
    buffer_load_dword v39, v63, s[36:39], s73 offen
    s_add_u32 s62, s62, 1
    s_cmp_eq_u32 s62, 10
    s_cselect_b32 s62, 0, s62
    buffer_load_dwordx4 v[136:139], v60, s[32:35], s72 offen
    buffer_load_dwordx4 v[140:143], v61, s[32:35], s72 offen
    buffer_load_dwordx4 v[144:147], v62, s[32:35], s72 offen
    s_add_u32 s72, s72, 12288
    buffer_load_dwordx4 v[148:151], v60, s[32:35], s72 offen
    buffer_load_dwordx4 v[152:155], v61, s[32:35], s72 offen
    buffer_load_dwordx4 v[156:159], v62, s[32:35], s72 offen
    s_mov_b32 s63, 0x3fb8aa3b
    s_mov_b32 s69, 0x01000100
    s_mov_b32 s70, 0x03020302
    s_mov_b32 s43, 0
    s_mov_b32 s45, 0
    s_mov_b32 s48, 0
    s_mov_b32 s47, 0
    s_mov_b32 s49, 0
    s_mov_b32 s50, 0
    s_mov_b32 s100, 0
    s_lshr_b32 s78, s2, 3
    s_and_b32 s78, s78, 15
    s_add_u32 s78, s78, 8
    s_cmp_eq_u32 s3, 1
    s_cselect_b32 s78, s78, 1000
    s_sub_u32 s66, s2, 64
    s_cmp_ge_u32 s3, 2
    s_cselect_b32 s65, s66, 100
    s_cmp_lt_u32 s65, 8
    s_cselect_b32 s78, 12, s78
    s_getreg_b32 s94, hwreg(HW_REG_XCC_ID)
    s_and_b32 s94, s94, 15
    s_bitcmp1_b32 s94, 0
    s_cselect_b32 s55, -3, 3
    s_and_b32 s95, s2, 7
    s_lshl_b32 s51, s95, 8
    s_add_u32 s51, s51, 753664
    s_lshr_b32 s52, s2, 3
    s_lshl_b32 s52, s52, 2
    s_add_u32 s52, s52, s51
    s_mov_b32 s54, 755712
    s_mul_i32 s65, s3, 6144
    v_mul_u32_u24 v1, 384, v48
    v_lshl_add_u32 v1, v49, 4, v1
    v_add_u32 v1, s65, v1
    v_mul_u32_u24 v2, 768, v50
    v_lshl_add_u32 v2, v51, 4, v2
    v_add_u32 v2, s65, v2
    v_and_b32 v52, 1, v0
    v_lshlrev_b32 v52, 4, v52
    v_mov_b32 v53, 0xffff
    v_lshlrev_b32 v52, v52, v53
    v_lshrrev_b32 v53, 1, v49
    v_cmp_eq_u32 vcc, 0, v53
    s_nop 1
    v_cndmask_b32 v3, 0, v52, vcc
    v_cmp_eq_u32 vcc, 1, v53
    s_nop 1
    v_cndmask_b32 v4, 0, v52, vcc
    v_cmp_eq_u32 vcc, 2, v53
    s_nop 1
    v_cndmask_b32 v5, 0, v52, vcc
    v_cmp_eq_u32 vcc, 3, v53
    s_nop 1
    v_cndmask_b32 v6, 0, v52, vcc
    v_and_b32 v52, 1, v50
    v_lshlrev_b32 v52, 4, v52
    v_lshl_add_u32 v52, v51, 5, v52
    v_cmp_gt_u32 vcc, 32, v0
    v_add_u32 v53, 768, v52
    v_add_u32 v11, 512, v52
    v_cndmask_b32 v10, v53, v52, vcc
    s_mul_i32 s66, s3, 1552
    s_add_u32 s66, s66, 153600
    v_add_u32 v10, s66, v10
    v_add_u32 v11, s66, v11
    v_mov_b32 v12, 0
    v_mov_b32 v13, 0
    v_mov_b32 v14, 0
    v_mov_b32 v15, 0
    v_mov_b32 v16, 0
    v_mov_b32 v17, 0
    v_mov_b32 v18, 0
    v_mov_b32 v19, 0
    v_mov_b32 v20, 0
    v_mov_b32 v21, 0
    v_mov_b32 v22, 0
    v_mov_b32 v23, 0
    v_mov_b32 v9, 0
    v_mov_b32 v8, 0xff167699
    v_mul_f32 v7, s63, v8
    v_mov_b32 v188, 1
    v_mov_b32 v191, 0
    v_mov_b32 v200, -1
    v_lshlrev_b32 v201, 2, v0
    v_mov_b32 v202, 0
    v_mov_b32 v205, 0
    v_mov_b32 v208, 0
    v_mov_b32 v209, 0
    v_mov_b32 v210, 0
    v_mov_b32 v211, 0
    v_mov_b32 v212, 0
    v_mov_b32 v213, 0
    v_mov_b32 v214, 0
    v_mov_b32 v215, 0
    v_mov_b32 v216, 0
    v_mov_b32 v217, 0
    v_mov_b32 v218, 0
    v_mov_b32 v219, 0
    v_mov_b32 v220, 0
    v_mov_b32 v221, 0
    v_mov_b32 v222, 0
    v_mov_b32 v223, 0
    v_mov_b32 v224, 0
    v_mov_b32 v225, 0
    v_mov_b32 v226, 0
    v_mov_b32 v227, 0
    v_mov_b32 v228, 0
    v_mov_b32 v229, 0
    v_mov_b32 v230, 0
    v_mov_b32 v231, 0
    v_mov_b32 v232, 0
    v_mov_b32 v233, 0
    v_mov_b32 v234, 0
    v_mov_b32 v235, 0
    v_mov_b32 v236, 0
    v_mov_b32 v237, 0
    v_mov_b32 v238, 0
    v_mov_b32 v239, 0
    s_waitcnt vmcnt(27)
    v_perm_b32 v50, v36, v36, s69
    v_and_b32 v52, v50, v3
    v_and_b32 v53, v50, v4
    v_and_b32 v54, v50, v5
    v_and_b32 v55, v50, v6
    s_waitcnt vmcnt(24)
    s_nop 0
    v_mfma_f32_16x16x32_bf16 v[12:15], v[52:55], v[64:67], v[12:15]
    v_mfma_f32_16x16x32_bf16 v[16:19], v[52:55], v[68:71], v[16:19]
    v_mfma_f32_16x16x32_bf16 v[20:23], v[52:55], v[72:75], v[20:23]
    s_lshl_b32 s73, s62, 7
    s_add_u32 s73, s73, s79
    s_mul_i32 s72, s62, 786432
    buffer_load_dword v40, v63, s[36:39], s73 offen
    s_add_u32 s62, s62, 1
    s_cmp_eq_u32 s62, 10
    s_cselect_b32 s62, 0, s62
    buffer_load_dwordx4 v[64:67], v60, s[32:35], s72 offen
    buffer_load_dwordx4 v[68:71], v61, s[32:35], s72 offen
    buffer_load_dwordx4 v[72:75], v62, s[32:35], s72 offen
    v_perm_b32 v50, v36, v36, s70
    v_and_b32 v56, v50, v3
    v_and_b32 v57, v50, v4
    v_and_b32 v58, v50, v5
    v_and_b32 v59, v50, v6
    s_waitcnt vmcnt(25)
    s_nop 0
    v_mfma_f32_16x16x32_bf16 v[12:15], v[56:59], v[76:79], v[12:15]
    v_mfma_f32_16x16x32_bf16 v[16:19], v[56:59], v[80:83], v[16:19]
    v_mfma_f32_16x16x32_bf16 v[20:23], v[56:59], v[84:87], v[20:23]
    s_add_u32 s72, s72, 12288
    buffer_load_dwordx4 v[76:79], v60, s[32:35], s72 offen
    buffer_load_dwordx4 v[80:83], v61, s[32:35], s72 offen
    buffer_load_dwordx4 v[84:87], v62, s[32:35], s72 offen
    s_waitcnt vmcnt(27)
    v_perm_b32 v50, v37, v37, s69
    v_and_b32 v52, v50, v3
    v_and_b32 v53, v50, v4
    v_and_b32 v54, v50, v5
    v_and_b32 v55, v50, v6
    s_waitcnt vmcnt(24)
    s_nop 0
    v_mfma_f32_16x16x32_bf16 v[12:15], v[52:55], v[88:91], v[12:15]
    v_mfma_f32_16x16x32_bf16 v[16:19], v[52:55], v[92:95], v[16:19]
    v_mfma_f32_16x16x32_bf16 v[20:23], v[52:55], v[96:99], v[20:23]
    s_lshl_b32 s73, s62, 7
    s_add_u32 s73, s73, s79
    s_mul_i32 s72, s62, 786432
    buffer_load_dword v41, v63, s[36:39], s73 offen
    s_add_u32 s62, s62, 1
    s_cmp_eq_u32 s62, 10
    s_cselect_b32 s62, 0, s62
    buffer_load_dwordx4 v[88:91], v60, s[32:35], s72 offen
    buffer_load_dwordx4 v[92:95], v61, s[32:35], s72 offen
    buffer_load_dwordx4 v[96:99], v62, s[32:35], s72 offen
    v_perm_b32 v50, v37, v37, s70
    v_and_b32 v56, v50, v3
    v_and_b32 v57, v50, v4
    v_and_b32 v58, v50, v5
    v_and_b32 v59, v50, v6
    s_waitcnt vmcnt(25)
    s_nop 0
    v_mfma_f32_16x16x32_bf16 v[12:15], v[56:59], v[100:103], v[12:15]
    v_mfma_f32_16x16x32_bf16 v[16:19], v[56:59], v[104:107], v[16:19]
    v_mfma_f32_16x16x32_bf16 v[20:23], v[56:59], v[108:111], v[20:23]
    s_add_u32 s72, s72, 12288
    buffer_load_dwordx4 v[100:103], v60, s[32:35], s72 offen
    buffer_load_dwordx4 v[104:107], v61, s[32:35], s72 offen
    buffer_load_dwordx4 v[108:111], v62, s[32:35], s72 offen
    s_waitcnt vmcnt(27)
    v_perm_b32 v50, v38, v38, s69
    v_and_b32 v52, v50, v3
    v_and_b32 v53, v50, v4
    v_and_b32 v54, v50, v5
    v_and_b32 v55, v50, v6
    s_waitcnt vmcnt(24)
    s_nop 0
    v_mfma_f32_16x16x32_bf16 v[12:15], v[52:55], v[112:115], v[12:15]
    v_mfma_f32_16x16x32_bf16 v[16:19], v[52:55], v[116:119], v[16:19]
    v_mfma_f32_16x16x32_bf16 v[20:23], v[52:55], v[120:123], v[20:23]
    s_lshl_b32 s73, s62, 7
    s_add_u32 s73, s73, s79
    s_mul_i32 s72, s62, 786432
    buffer_load_dword v42, v63, s[36:39], s73 offen
    s_add_u32 s62, s62, 1
    s_cmp_eq_u32 s62, 10
    s_cselect_b32 s62, 0, s62
    buffer_load_dwordx4 v[112:115], v60, s[32:35], s72 offen
    buffer_load_dwordx4 v[116:119], v61, s[32:35], s72 offen
    buffer_load_dwordx4 v[120:123], v62, s[32:35], s72 offen
    v_perm_b32 v50, v38, v38, s70
    v_and_b32 v56, v50, v3
    v_and_b32 v57, v50, v4
    v_and_b32 v58, v50, v5
    v_and_b32 v59, v50, v6
    s_waitcnt vmcnt(25)
    s_nop 0
    v_mfma_f32_16x16x32_bf16 v[12:15], v[56:59], v[124:127], v[12:15]
    v_mfma_f32_16x16x32_bf16 v[16:19], v[56:59], v[128:131], v[16:19]
    v_mfma_f32_16x16x32_bf16 v[20:23], v[56:59], v[132:135], v[20:23]
    s_add_u32 s72, s72, 12288
    buffer_load_dwordx4 v[124:127], v60, s[32:35], s72 offen
    buffer_load_dwordx4 v[128:131], v61, s[32:35], s72 offen
    buffer_load_dwordx4 v[132:135], v62, s[32:35], s72 offen
    s_waitcnt vmcnt(27)
    v_perm_b32 v50, v39, v39, s69
    v_and_b32 v52, v50, v3
    v_and_b32 v53, v50, v4
    v_and_b32 v54, v50, v5
    v_and_b32 v55, v50, v6
    s_waitcnt vmcnt(24)
    s_nop 0
    v_mfma_f32_16x16x32_bf16 v[12:15], v[52:55], v[136:139], v[12:15]
    v_mfma_f32_16x16x32_bf16 v[16:19], v[52:55], v[140:143], v[16:19]
    v_mfma_f32_16x16x32_bf16 v[20:23], v[52:55], v[144:147], v[20:23]
    s_lshl_b32 s73, s62, 7
    s_add_u32 s73, s73, s79
    s_mul_i32 s72, s62, 786432
    buffer_load_dword v43, v63, s[36:39], s73 offen
    s_add_u32 s62, s62, 1
    s_cmp_eq_u32 s62, 10
    s_cselect_b32 s62, 0, s62
    buffer_load_dwordx4 v[136:139], v60, s[32:35], s72 offen
    buffer_load_dwordx4 v[140:143], v61, s[32:35], s72 offen
    buffer_load_dwordx4 v[144:147], v62, s[32:35], s72 offen
    v_perm_b32 v50, v39, v39, s70
    v_and_b32 v56, v50, v3
    v_and_b32 v57, v50, v4
    v_and_b32 v58, v50, v5
    v_and_b32 v59, v50, v6
    s_waitcnt vmcnt(25)
    s_nop 0
    v_mfma_f32_16x16x32_bf16 v[12:15], v[56:59], v[148:151], v[12:15]
    v_mfma_f32_16x16x32_bf16 v[16:19], v[56:59], v[152:155], v[16:19]
    v_mfma_f32_16x16x32_bf16 v[20:23], v[56:59], v[156:159], v[20:23]
    s_add_u32 s72, s72, 12288
    buffer_load_dwordx4 v[148:151], v60, s[32:35], s72 offen
    buffer_load_dwordx4 v[152:155], v61, s[32:35], s72 offen
    buffer_load_dwordx4 v[156:159], v62, s[32:35], s72 offen
    s_waitcnt vmcnt(27)
    v_perm_b32 v50, v40, v40, s69
    v_and_b32 v52, v50, v3
    v_and_b32 v53, v50, v4
    v_and_b32 v54, v50, v5
    v_and_b32 v55, v50, v6
    s_waitcnt vmcnt(24)
    s_nop 0
    v_mfma_f32_16x16x32_bf16 v[12:15], v[52:55], v[64:67], v[12:15]
    v_mfma_f32_16x16x32_bf16 v[16:19], v[52:55], v[68:71], v[16:19]
    v_mfma_f32_16x16x32_bf16 v[20:23], v[52:55], v[72:75], v[20:23]
    s_lshl_b32 s73, s62, 7
    s_add_u32 s73, s73, s79
    s_mul_i32 s72, s62, 786432
    buffer_load_dword v44, v63, s[36:39], s73 offen
    s_add_u32 s62, s62, 1
    s_cmp_eq_u32 s62, 10
    s_cselect_b32 s62, 0, s62
    buffer_load_dwordx4 v[64:67], v60, s[32:35], s72 offen
    buffer_load_dwordx4 v[68:71], v61, s[32:35], s72 offen
    buffer_load_dwordx4 v[72:75], v62, s[32:35], s72 offen
    v_perm_b32 v50, v40, v40, s70
    v_and_b32 v56, v50, v3
    v_and_b32 v57, v50, v4
    v_and_b32 v58, v50, v5
    v_and_b32 v59, v50, v6
    s_waitcnt vmcnt(25)
    s_nop 0
    v_mfma_f32_16x16x32_bf16 v[12:15], v[56:59], v[76:79], v[12:15]
    v_mfma_f32_16x16x32_bf16 v[16:19], v[56:59], v[80:83], v[16:19]
    v_mfma_f32_16x16x32_bf16 v[20:23], v[56:59], v[84:87], v[20:23]
    s_add_u32 s72, s72, 12288
    buffer_load_dwordx4 v[76:79], v60, s[32:35], s72 offen
    buffer_load_dwordx4 v[80:83], v61, s[32:35], s72 offen
    buffer_load_dwordx4 v[84:87], v62, s[32:35], s72 offen
    s_waitcnt vmcnt(27)
    v_perm_b32 v50, v41, v41, s69
    v_and_b32 v52, v50, v3
    v_and_b32 v53, v50, v4
    v_and_b32 v54, v50, v5
    v_and_b32 v55, v50, v6
    s_waitcnt vmcnt(24)
    s_nop 0
    v_mfma_f32_16x16x32_bf16 v[12:15], v[52:55], v[88:91], v[12:15]
    v_mfma_f32_16x16x32_bf16 v[16:19], v[52:55], v[92:95], v[16:19]
    v_mfma_f32_16x16x32_bf16 v[20:23], v[52:55], v[96:99], v[20:23]
    s_lshl_b32 s73, s62, 7
    s_add_u32 s73, s73, s79
    s_mul_i32 s72, s62, 786432
    buffer_load_dword v45, v63, s[36:39], s73 offen
    s_add_u32 s62, s62, 1
    s_cmp_eq_u32 s62, 10
    s_cselect_b32 s62, 0, s62
    buffer_load_dwordx4 v[88:91], v60, s[32:35], s72 offen
    buffer_load_dwordx4 v[92:95], v61, s[32:35], s72 offen
    buffer_load_dwordx4 v[96:99], v62, s[32:35], s72 offen
    v_perm_b32 v50, v41, v41, s70
    v_and_b32 v56, v50, v3
    v_and_b32 v57, v50, v4
    v_and_b32 v58, v50, v5
    v_and_b32 v59, v50, v6
    s_waitcnt vmcnt(25)
    s_nop 0
    v_mfma_f32_16x16x32_bf16 v[12:15], v[56:59], v[100:103], v[12:15]
    v_mfma_f32_16x16x32_bf16 v[16:19], v[56:59], v[104:107], v[16:19]
    v_mfma_f32_16x16x32_bf16 v[20:23], v[56:59], v[108:111], v[20:23]
    s_add_u32 s72, s72, 12288
    buffer_load_dwordx4 v[100:103], v60, s[32:35], s72 offen
    buffer_load_dwordx4 v[104:107], v61, s[32:35], s72 offen
    buffer_load_dwordx4 v[108:111], v62, s[32:35], s72 offen
    s_barrier
    s_waitcnt vmcnt(27)
    v_perm_b32 v50, v42, v42, s69
    v_and_b32 v52, v50, v3
    v_and_b32 v53, v50, v4
    v_and_b32 v54, v50, v5
    v_and_b32 v55, v50, v6
    s_waitcnt vmcnt(24)
    s_nop 0
    v_mfma_f32_16x16x32_bf16 v[12:15], v[52:55], v[112:115], v[12:15]
    v_mfma_f32_16x16x32_bf16 v[16:19], v[52:55], v[116:119], v[16:19]
    v_mfma_f32_16x16x32_bf16 v[20:23], v[52:55], v[120:123], v[20:23]
    v_perm_b32 v50, v42, v42, s70
    v_and_b32 v56, v50, v3
    v_and_b32 v57, v50, v4
    v_and_b32 v58, v50, v5
    v_and_b32 v59, v50, v6
    s_waitcnt vmcnt(21)
    s_nop 0
    v_mfma_f32_16x16x32_bf16 v[12:15], v[56:59], v[124:127], v[12:15]
    v_mfma_f32_16x16x32_bf16 v[16:19], v[56:59], v[128:131], v[16:19]
    v_mfma_f32_16x16x32_bf16 v[20:23], v[56:59], v[132:135], v[20:23]
    s_waitcnt vmcnt(20)
    v_perm_b32 v50, v43, v43, s69
    v_and_b32 v52, v50, v3
    v_and_b32 v53, v50, v4
    v_and_b32 v54, v50, v5
    v_and_b32 v55, v50, v6
    s_waitcnt vmcnt(17)
    s_nop 0
    v_mfma_f32_16x16x32_bf16 v[12:15], v[52:55], v[136:139], v[12:15]
    v_mfma_f32_16x16x32_bf16 v[16:19], v[52:55], v[140:143], v[16:19]
    v_mfma_f32_16x16x32_bf16 v[20:23], v[52:55], v[144:147], v[20:23]
    v_perm_b32 v50, v43, v43, s70
    v_and_b32 v56, v50, v3
    v_and_b32 v57, v50, v4
    v_and_b32 v58, v50, v5
    v_and_b32 v59, v50, v6
    s_waitcnt vmcnt(14)
    s_nop 0
    v_mfma_f32_16x16x32_bf16 v[12:15], v[56:59], v[148:151], v[12:15]
    v_mfma_f32_16x16x32_bf16 v[16:19], v[56:59], v[152:155], v[16:19]
    v_mfma_f32_16x16x32_bf16 v[20:23], v[56:59], v[156:159], v[20:23]
    s_waitcnt vmcnt(13)
    v_perm_b32 v50, v44, v44, s69
    v_and_b32 v52, v50, v3
    v_and_b32 v53, v50, v4
    v_and_b32 v54, v50, v5
    v_and_b32 v55, v50, v6
    s_waitcnt vmcnt(10)
    s_nop 0
    v_mfma_f32_16x16x32_bf16 v[12:15], v[52:55], v[64:67], v[12:15]
    v_mfma_f32_16x16x32_bf16 v[16:19], v[52:55], v[68:71], v[16:19]
    v_mfma_f32_16x16x32_bf16 v[20:23], v[52:55], v[72:75], v[20:23]
    v_perm_b32 v50, v44, v44, s70
    v_and_b32 v56, v50, v3
    v_and_b32 v57, v50, v4
    v_and_b32 v58, v50, v5
    v_and_b32 v59, v50, v6
    s_waitcnt vmcnt(7)
    s_nop 0
    v_mfma_f32_16x16x32_bf16 v[12:15], v[56:59], v[76:79], v[12:15]
    v_mfma_f32_16x16x32_bf16 v[16:19], v[56:59], v[80:83], v[16:19]
    v_mfma_f32_16x16x32_bf16 v[20:23], v[56:59], v[84:87], v[20:23]
    s_waitcnt vmcnt(6)
    v_perm_b32 v50, v45, v45, s69
    v_and_b32 v52, v50, v3
    v_and_b32 v53, v50, v4
    v_and_b32 v54, v50, v5
    v_and_b32 v55, v50, v6
    s_waitcnt vmcnt(3)
    s_nop 0
    v_mfma_f32_16x16x32_bf16 v[12:15], v[52:55], v[88:91], v[12:15]
    v_mfma_f32_16x16x32_bf16 v[16:19], v[52:55], v[92:95], v[16:19]
    v_mfma_f32_16x16x32_bf16 v[20:23], v[52:55], v[96:99], v[20:23]
    v_perm_b32 v50, v45, v45, s70
    v_and_b32 v56, v50, v3
    v_and_b32 v57, v50, v4
    v_and_b32 v58, v50, v5
    v_and_b32 v59, v50, v6
    s_waitcnt vmcnt(0)
    s_nop 0
    v_mfma_f32_16x16x32_bf16 v[12:15], v[56:59], v[100:103], v[12:15]
    v_mfma_f32_16x16x32_bf16 v[16:19], v[56:59], v[104:107], v[16:19]
    v_mfma_f32_16x16x32_bf16 v[20:23], v[56:59], v[108:111], v[20:23]
    s_mul_i32 s65, s3, 384
    s_add_u32 s65, s65, 159808
    v_lshl_add_u32 v57, v0, 3, s65
    v_lshl_add_u32 v58, v49, 4, s65
    s_mov_b32 s66, 153600
    v_lshl_add_u32 v56, v0, 4, s66
    v_mov_b32 v46, 161344
    v_mov_b32 v47, 0
    s_mov_b32 exec_hi, 0
    ds_write_b128 v10, v[12:15]
    s_mov_b32 exec_lo, 0
    s_mov_b32 exec_hi, -1
    ds_write_b128 v10, v[20:23] offset:256
    s_mov_b32 exec_lo, 0x00ff00ff
    s_mov_b32 exec_hi, 0xff00ff00
    ds_write_b128 v11, v[16:19]
    s_mov_b64 exec, -1
    s_waitcnt lgkmcnt(0)
    s_mov_b64 exec, 1
    ds_add_u32 v46, v188 offset:32
    s_mov_b64 exec, -1
L_meet1:
    ds_read_b32 v63, v46 offset:32
    s_add_u32 s48, s48, 1
    s_waitcnt lgkmcnt(0)
    v_readfirstlane_b32 s65, v63
    s_cmp_gt_u32 s48, 16777216
    s_cselect_b32 s65, 4, s65
    s_cmp_lt_u32 s65, 4
    s_cbranch_scc1 L_meet1
    s_mov_b32 exec_hi, 0xffff
    ds_read_b128 v[24:27], v56 offset:0
    ds_read_b128 v[28:31], v56 offset:768
    ds_read_b128 v[32:35], v56 offset:1552
    ds_read_b128 v[36:39], v56 offset:2320
    ds_read_b128 v[40:43], v56 offset:3104
    ds_read_b128 v[64:67], v56 offset:3872
    ds_read_b128 v[12:15], v56 offset:4656
    ds_read_b128 v[16:19], v56 offset:5424
    s_waitcnt lgkmcnt(6)
    v_add_f32 v24, v24, v28
    v_add_f32 v25, v25, v29
    v_add_f32 v26, v26, v30
    v_add_f32 v27, v27, v31
    s_waitcnt lgkmcnt(5)
    v_add_f32 v24, v24, v32
    v_add_f32 v25, v25, v33
    v_add_f32 v26, v26, v34
    v_add_f32 v27, v27, v35
    s_waitcnt lgkmcnt(4)
    v_add_f32 v24, v24, v36
    v_add_f32 v25, v25, v37
    v_add_f32 v26, v26, v38
    v_add_f32 v27, v27, v39
    s_waitcnt lgkmcnt(3)
    v_add_f32 v24, v24, v40
    v_add_f32 v25, v25, v41
    v_add_f32 v26, v26, v42
    v_add_f32 v27, v27, v43
    s_waitcnt lgkmcnt(2)
    v_add_f32 v24, v24, v64
    v_add_f32 v25, v25, v65
    v_add_f32 v26, v26, v66
    v_add_f32 v27, v27, v67
    s_waitcnt lgkmcnt(1)
    v_add_f32 v24, v24, v12
    v_add_f32 v25, v25, v13
    v_add_f32 v26, v26, v14
    v_add_f32 v27, v27, v15
    s_waitcnt lgkmcnt(0)
    v_add_f32 v24, v24, v16
    v_add_f32 v25, v25, v17
    v_add_f32 v26, v26, v18
    v_add_f32 v27, v27, v19
    v_cvt_pk_bf16_f32 v24, v24, v25
    v_cvt_pk_bf16_f32 v25, v26, v27
    ds_write_b64 v57, v[24:25]
    s_mov_b32 exec_hi, -1
    v_mov_b32 v12, 0
    v_mov_b32 v13, 0
    v_mov_b32 v14, 0
    v_mov_b32 v15, 0
    v_mov_b32 v16, 0
    v_mov_b32 v17, 0
    v_mov_b32 v18, 0
    v_mov_b32 v19, 0
    v_mov_b32 v20, 0
    v_mov_b32 v21, 0
    v_mov_b32 v22, 0
    v_mov_b32 v23, 0
    s_lshl_b32 s65, s3, 2
    s_add_u32 s65, s65, 161360
    v_mov_b32 v45, s65
    s_add_u32 s46, s3, 1
    s_waitcnt lgkmcnt(0)
    ds_read_b128 v[24:27], v58 offset:0
    ds_read_b128 v[28:31], v58 offset:128
    ds_read_b128 v[32:35], v58 offset:256
    s_cmp_ge_u32 s2, 32
    s_cbranch_scc1 L_nosig
    s_cmp_lg_u32 s3, 3
    s_cbranch_scc1 L_nosig
    s_mov_b64 exec, 1
    global_atomic_add v202, v188, s[16:17]
    s_mov_b64 exec, -1
L_nosig:
.p2align 6
L_batch:
    v_mov_b32 v60, v8
L_kloop:
    v_add_u32 v62, s47, v1
    s_cmp_ge_u32 s45, s46
    s_cbranch_scc1 L_havek
L_pollk:
    ds_read_b32 v63, v46 offset:0
    s_add_u32 s48, s48, 1
    s_waitcnt lgkmcnt(0)
    v_readfirstlane_b32 s45, v63
    s_cmp_ge_u32 s45, s46
    s_cbranch_scc1 L_havek
    s_cmp_gt_u32 s48, 16777216
    s_cbranch_scc0 L_pollk
L_havek:
    ds_read_b128 v[64:67], v62 offset:0
    ds_read_b128 v[68:71], v62 offset:128
    ds_read_b128 v[72:75], v62 offset:256
    ds_read_b128 v[76:79], v62 offset:3072
    ds_read_b128 v[80:83], v62 offset:3200
    ds_read_b128 v[84:87], v62 offset:3328
    s_add_u32 s47, s47, 24576
    s_cmp_eq_u32 s47, 122880
    s_cselect_b32 s47, 0, s47
    v_mov_b32 v48, 0
    v_mov_b32 v49, 0
    v_add_u32 v47, 1, v47
    s_add_u32 s46, s46, 4
    v_mov_b32 v208, v210
    v_mov_b32 v209, v211
    v_mov_b32 v210, v212
    v_mov_b32 v211, v213
    v_mov_b32 v212, v214
    v_mov_b32 v213, v215
    v_mov_b32 v214, v216
    v_mov_b32 v215, v217
    v_mov_b32 v216, v218
    v_mov_b32 v217, v219
    v_mov_b32 v218, v220
    v_mov_b32 v219, v221
    v_mov_b32 v220, v222
    v_mov_b32 v221, v223
    v_mov_b32 v222, v224
    v_mov_b32 v223, v225
    v_mov_b32 v224, v226
    v_mov_b32 v225, v227
    v_mov_b32 v226, v228
    v_mov_b32 v227, v229
    v_mov_b32 v228, v230
    v_mov_b32 v229, v231
    v_mov_b32 v230, v232
    v_mov_b32 v231, v233
    v_mov_b32 v232, v234
    v_mov_b32 v233, v235
    v_mov_b32 v234, v236
    v_mov_b32 v235, v237
    v_mov_b32 v236, v238
    v_mov_b32 v237, v239
    s_waitcnt lgkmcnt(0)
    ds_write_b32 v45, v47
    v_dot2c_f32_bf16 v48, v64, v24
    v_dot2c_f32_bf16 v49, v76, v24
    v_dot2c_f32_bf16 v48, v65, v25
    v_dot2c_f32_bf16 v49, v77, v25
    v_dot2c_f32_bf16 v48, v66, v26
    v_dot2c_f32_bf16 v49, v78, v26
    v_dot2c_f32_bf16 v48, v67, v27
    v_dot2c_f32_bf16 v49, v79, v27
    v_dot2c_f32_bf16 v48, v68, v28
    v_dot2c_f32_bf16 v49, v80, v28
    v_dot2c_f32_bf16 v48, v69, v29
    v_dot2c_f32_bf16 v49, v81, v29
    v_dot2c_f32_bf16 v48, v70, v30
    v_dot2c_f32_bf16 v49, v82, v30
    v_dot2c_f32_bf16 v48, v71, v31
    v_dot2c_f32_bf16 v49, v83, v31
    v_dot2c_f32_bf16 v48, v72, v32
    v_dot2c_f32_bf16 v49, v84, v32
    v_dot2c_f32_bf16 v48, v73, v33
    v_dot2c_f32_bf16 v49, v85, v33
    v_dot2c_f32_bf16 v48, v74, v34
    v_dot2c_f32_bf16 v49, v86, v34
    v_dot2c_f32_bf16 v48, v75, v35
    v_dot2c_f32_bf16 v49, v87, v35
    s_add_u32 s43, s43, 1
    s_cmp_ge_u32 s43, s78
    s_mov_b32 s56, 0
    s_cbranch_scc1 L_side
L_side_ret0:
    v_add_f32_dpp v48, v48, v48 quad_perm:[1,0,3,2] row_mask:0xf bank_mask:0xf
    v_add_f32_dpp v49, v49, v49 quad_perm:[1,0,3,2] row_mask:0xf bank_mask:0xf
    s_nop 0
    v_add_f32_dpp v48, v48, v48 quad_perm:[2,3,0,1] row_mask:0xf bank_mask:0xf
    v_add_f32_dpp v49, v49, v49 quad_perm:[2,3,0,1] row_mask:0xf bank_mask:0xf
    s_nop 0
    v_add_f32_dpp v238, v48, v48 row_half_mirror row_mask:0xf bank_mask:0xf
    v_add_f32_dpp v239, v49, v49 row_half_mirror row_mask:0xf bank_mask:0xf
    v_cvt_pk_bf16_f32 v50, v238, v239
    v_lshlrev_b32 v238, 16, v50
    v_and_b32 v239, 0xffff0000, v50
    v_mul_f32 v238, 0x3d93cd3a, v238
    v_mul_f32 v239, 0x3d93cd3a, v239
    v_cvt_pk_bf16_f32 v50, v238, v239
    v_lshlrev_b32 v238, 16, v50
    v_and_b32 v239, 0xffff0000, v50
    s_and_b32 s65, s43, 15
    s_cmp_lg_u32 s65, 0
    v_max3_f32 v60, v60, v238, v239
    s_cbranch_scc1 L_kloop
    v_cmp_gt_f32 vcc, v60, v8
    s_cbranch_vccnz L_resc
L_back:
    v_fma_f32 v208, v208, s63, -v7
    v_fma_f32 v209, v209, s63, -v7
    v_fma_f32 v210, v210, s63, -v7
    v_fma_f32 v211, v211, s63, -v7
    v_fma_f32 v212, v212, s63, -v7
    v_fma_f32 v213, v213, s63, -v7
    v_fma_f32 v214, v214, s63, -v7
    v_fma_f32 v215, v215, s63, -v7
    v_fma_f32 v216, v216, s63, -v7
    v_fma_f32 v217, v217, s63, -v7
    v_fma_f32 v218, v218, s63, -v7
    v_fma_f32 v219, v219, s63, -v7
    v_fma_f32 v220, v220, s63, -v7
    v_fma_f32 v221, v221, s63, -v7
    v_fma_f32 v222, v222, s63, -v7
    v_fma_f32 v223, v223, s63, -v7
    v_fma_f32 v224, v224, s63, -v7
    v_fma_f32 v225, v225, s63, -v7
    v_fma_f32 v226, v226, s63, -v7
    v_fma_f32 v227, v227, s63, -v7
    v_fma_f32 v228, v228, s63, -v7
    v_fma_f32 v229, v229, s63, -v7
    v_fma_f32 v230, v230, s63, -v7
    v_fma_f32 v231, v231, s63, -v7
    v_fma_f32 v232, v232, s63, -v7
    v_fma_f32 v233, v233, s63, -v7
    v_fma_f32 v234, v234, s63, -v7
    v_fma_f32 v235, v235, s63, -v7
    v_fma_f32 v236, v236, s63, -v7
    v_fma_f32 v237, v237, s63, -v7
    v_fma_f32 v238, v238, s63, -v7
    v_fma_f32 v239, v239, s63, -v7
    v_exp_f32 v208, v208
    v_exp_f32 v209, v209
    v_exp_f32 v210, v210
    v_exp_f32 v211, v211
    v_exp_f32 v212, v212
    v_exp_f32 v213, v213
    v_exp_f32 v214, v214
    v_exp_f32 v215, v215
    v_exp_f32 v216, v216
    v_exp_f32 v217, v217
    v_exp_f32 v218, v218
    v_exp_f32 v219, v219
    v_exp_f32 v220, v220
    v_exp_f32 v221, v221
    v_exp_f32 v222, v222
    v_exp_f32 v223, v223
    v_exp_f32 v224, v224
    v_exp_f32 v225, v225
    v_exp_f32 v226, v226
    v_exp_f32 v227, v227
    v_exp_f32 v228, v228
    v_exp_f32 v229, v229
    v_exp_f32 v230, v230
    v_exp_f32 v231, v231
    v_exp_f32 v232, v232
    v_exp_f32 v233, v233
    v_exp_f32 v234, v234
    v_exp_f32 v235, v235
    v_exp_f32 v236, v236
    v_exp_f32 v237, v237
    v_exp_f32 v238, v238
    v_exp_f32 v239, v239
    s_cmp_eq_u32 s43, 112
    v_add_f32 v9, v9, v208
    v_add_f32 v9, v9, v209
    v_add_f32 v9, v9, v210
    v_add_f32 v9, v9, v211
    v_add_f32 v9, v9, v212
    v_add_f32 v9, v9, v213
    v_add_f32 v9, v9, v214
    v_add_f32 v9, v9, v215
    v_add_f32 v9, v9, v216
    v_add_f32 v9, v9, v217
    v_add_f32 v9, v9, v218
    v_add_f32 v9, v9, v219
    v_add_f32 v9, v9, v220
    v_add_f32 v9, v9, v221
    v_add_f32 v9, v9, v222
    v_add_f32 v9, v9, v223
    v_add_f32 v9, v9, v224
    v_add_f32 v9, v9, v225
    v_add_f32 v9, v9, v226
    v_add_f32 v9, v9, v227
    v_add_f32 v9, v9, v228
    v_add_f32 v9, v9, v229
    v_add_f32 v9, v9, v230
    v_add_f32 v9, v9, v231
    v_add_f32 v9, v9, v232
    v_add_f32 v9, v9, v233
    v_add_f32 v9, v9, v234
    v_add_f32 v9, v9, v235
    v_add_f32 v9, v9, v236
    v_add_f32 v9, v9, v237
    v_add_f32 v9, v9, v238
    v_add_f32 v9, v9, v239
    s_cbranch_scc1 L_last
L_vloop:
    v_add_u32 v62, s47, v2
    v_cvt_pk_bf16_f32 v50, v208, v208
    v_cvt_pk_bf16_f32 v51, v209, v209
    v_mov_b32 v208, v210
    v_mov_b32 v209, v211
    v_mov_b32 v210, v212
    v_mov_b32 v211, v213
    v_mov_b32 v212, v214
    v_mov_b32 v213, v215
    v_mov_b32 v214, v216
    v_mov_b32 v215, v217
    v_mov_b32 v216, v218
    v_mov_b32 v217, v219
    v_mov_b32 v218, v220
    v_mov_b32 v219, v221
    v_mov_b32 v220, v222
    v_mov_b32 v221, v223
    v_mov_b32 v222, v224
    v_mov_b32 v223, v225
    v_mov_b32 v224, v226
    v_mov_b32 v225, v227
    v_mov_b32 v226, v228
    v_mov_b32 v227, v229
    v_mov_b32 v228, v230
    v_mov_b32 v229, v231
    v_mov_b32 v230, v232
    v_mov_b32 v231, v233
    v_mov_b32 v232, v234
    v_mov_b32 v233, v235
    v_mov_b32 v234, v236
    v_mov_b32 v235, v237
    v_mov_b32 v236, v238
    v_mov_b32 v237, v239
    v_and_b32 v52, v50, v3
    v_and_b32 v53, v50, v4
    v_and_b32 v54, v50, v5
    v_and_b32 v55, v50, v6
    v_and_b32 v56, v51, v3
    v_and_b32 v57, v51, v4
    v_and_b32 v58, v51, v5
    v_and_b32 v59, v51, v6
    s_cmp_ge_u32 s45, s46
    s_cbranch_scc1 L_havev
L_pollv:
    ds_read_b32 v63, v46 offset:0
    s_add_u32 s48, s48, 1
    s_waitcnt lgkmcnt(0)
    v_readfirstlane_b32 s45, v63
    s_cmp_ge_u32 s45, s46
    s_cbranch_scc1 L_havev
    s_cmp_gt_u32 s48, 16777216
    s_cbranch_scc0 L_pollv
L_havev:
    ds_read_b128 v[88:91], v62 offset:0
    ds_read_b128 v[92:95], v62 offset:256
    ds_read_b128 v[96:99], v62 offset:512
    ds_read_b128 v[100:103], v62 offset:3072
    ds_read_b128 v[104:107], v62 offset:3328
    ds_read_b128 v[108:111], v62 offset:3584
    s_add_u32 s47, s47, 24576
    s_cmp_eq_u32 s47, 122880
    s_cselect_b32 s47, 0, s47
    v_add_u32 v47, 1, v47
    s_add_u32 s46, s46, 4
    s_waitcnt lgkmcnt(5)
    v_mfma_f32_16x16x32_bf16 v[12:15], v[52:55], v[88:91], v[12:15]
    s_waitcnt lgkmcnt(4)
    v_mfma_f32_16x16x32_bf16 v[16:19], v[52:55], v[92:95], v[16:19]
    s_waitcnt lgkmcnt(3)
    v_mfma_f32_16x16x32_bf16 v[20:23], v[52:55], v[96:99], v[20:23]
    s_waitcnt lgkmcnt(2)
    v_mfma_f32_16x16x32_bf16 v[12:15], v[56:59], v[100:103], v[12:15]
    s_waitcnt lgkmcnt(1)
    v_mfma_f32_16x16x32_bf16 v[16:19], v[56:59], v[104:107], v[16:19]
    s_waitcnt lgkmcnt(0)
    v_mfma_f32_16x16x32_bf16 v[20:23], v[56:59], v[108:111], v[20:23]
    s_cmp_eq_u32 s43, 127
    s_cbranch_scc1 L_done
    ds_write_b32 v45, v47
    s_add_u32 s43, s43, 1
    s_cmp_ge_u32 s43, s78
    s_mov_b32 s56, 1
    s_cbranch_scc1 L_side
L_side_ret1:
    s_and_b32 s65, s43, 15
    s_cmp_lg_u32 s65, 0
    s_cbranch_scc1 L_vloop
    s_branch L_batch
L_resc:
    v_max_f32_dpp v50, v60, v60 row_ror:8 row_mask:0xf bank_mask:0xf
    s_nop 0
    v_mov_b32 v51, v50
    s_nop 1
    v_permlane16_swap_b32 v51, v50
    v_max_f32 v50, v50, v51
    v_mov_b32 v51, v50
    s_nop 1
    v_permlane32_swap_b32 v51, v50
    v_max_f32 v8, v50, v51
    v_mul_f32 v50, s63, v8
    v_sub_f32 v51, v7, v50
    v_exp_f32 v51, v51
    v_mov_b32 v7, v50
    v_mul_f32 v9, v9, v51
    v_mul_f32 v12, v12, v51
    v_mul_f32 v13, v13, v51
    v_mul_f32 v14, v14, v51
    v_mul_f32 v15, v15, v51
    v_mul_f32 v16, v16, v51
    v_mul_f32 v17, v17, v51
    v_mul_f32 v18, v18, v51
    v_mul_f32 v19, v19, v51
    v_mul_f32 v20, v20, v51
    v_mul_f32 v21, v21, v51
    v_mul_f32 v22, v22, v51
    v_mul_f32 v23, v23, v51
    s_branch L_back
L_side:
    s_cmp_lg_u32 s49, 0
    s_cbranch_scc1 L_ctl
L_ask:
    s_load_dword s65, s[16:17], 0 glc
    s_add_u32 s48, s48, 4
    s_cmp_gt_u32 s48, 16777216
    s_waitcnt lgkmcnt(0)
    s_cbranch_scc1 L_ready
    s_cmp_ge_u32 s65, 32
    s_cbranch_scc1 L_ready
    s_cmp_ge_u32 s43, 104
    s_cbranch_scc1 L_ask
    s_branch L_side_ret
L_ready:
    s_mov_b32 s49, s3
    s_cmp_ge_u32 s3, 2
    s_cbranch_scc0 L_side_ret
    v_mul_u32_u24 v201, 768, v0
    s_mul_i32 s52, s95, 768
    s_add_u32 s52, s52, 755712
    s_branch L_side_ret
L_ctl:
    s_cmp_ge_u32 s49, 2
    s_cbranch_scc1 L_glb
    s_waitcnt vmcnt(0)
    s_cmp_lg_u32 s43, 106
    s_cbranch_scc1 L_nofast
    v_and_b32 v203, 0x8000000f, v200
    v_cmp_eq_u32 vcc, s94, v203
    s_bfe_u32 s65, s2, 0x20003
    s_lshl_b32 s65, 0x11111111, s65
    s_and_b32 s66, vcc_lo, s65
    s_cmp_eq_u32 s66, s65
    s_cselect_b32 s65, 1, 0
    v_mov_b32 v203, s65
    ds_write_b32 v46, v203 offset:12
L_nofast:
    s_mov_b32 exec_hi, 1
    s_add_u32 s65, s50, 16
    v_cmp_le_i32 s[72:73], s65, v200
    v_cmp_le_i32 vcc, s50, v200
    v_readlane_b32 s67, v200, 32
    s_lshl_b32 s50, s43, 4
    s_or_b32 s66, s50, s94
    v_mov_b32 v204, s66
    s_bcnt1_i32_b32 s65, vcc_lo
    buffer_load_dword v200, v201, s[28:31], s51 offen nt
    s_mov_b64 exec, 1
    buffer_store_dword v204, v202, s[28:31], s52 offen
    s_add_i32 s67, s67, 1
    s_add_i32 s65, s65, s67
    s_add_i32 s65, s65, s55
    s_mov_b32 s66, 0
    s_cmp_ge_i32 s65, 12
    s_cselect_b32 s66, 1, s66
    s_cmp_ge_i32 s65, 25
    s_cselect_b32 s66, 2, s66
    s_bcnt1_i32_b32 s65, s72
    s_cmp_ge_u32 s65, 16
    s_cselect_b32 s66, 3, s66
    s_cmp_lt_u32 s43, 24
    s_cselect_b32 s66, 1, s66
    v_mov_b32 v203, s66
    ds_write_b32 v46, v203 offset:8
    s_mov_b64 exec, -1
    s_branch L_side_ret
L_glb:
    s_and_b32 s65, s43, 15
    s_cmp_eq_u32 s49, 2
    s_cbranch_scc1 L_glb_read
    s_cmp_lg_u32 s65, 0
    s_cbranch_scc1 L_side_ret
    s_cmp_gt_u32 s43, 120
    s_cbranch_scc1 L_side_ret
    v_mov_b32 v204, s43
    s_mov_b64 exec, 1
    buffer_store_dword v204, v202, s[28:31], s52 offen sc1
    s_mov_b64 exec, -1
    s_branch L_side_ret
L_glb_read:
    s_mov_b64 exec, 0xff
    s_waitcnt vmcnt(0)
    v_add_u32 v205, v205, v200
    buffer_load_dword v200, v201, s[28:31], s54 offen sc1
    s_cmp_eq_u32 s65, 10
    s_cbranch_scc0 L_glb_done
    v_readlane_b32 s66, v205, s95
    v_add_u32_dpp v206, v205, v205 quad_perm:[1,0,3,2] row_mask:0xf bank_mask:0xf
    v_mov_b32 v205, 0
    s_nop 0
    v_add_u32_dpp v206, v206, v206 quad_perm:[2,3,0,1] row_mask:0xf bank_mask:0xf
    s_nop 1
    v_add_u32_dpp v206, v206, v206 row_half_mirror row_mask:0xf bank_mask:0xf
    s_lshl_b32 s66, s66, 3
    v_readfirstlane_b32 s67, v206
    s_sub_i32 s66, s67, s66
    s_mul_i32 s66, s66, 3
    s_ashr_i32 s66, s66, 5
    s_min_i32 s66, s66, 11
    s_max_i32 s66, s66, -11
    s_cmp_lt_u32 s43, 24
    s_cselect_b32 s66, 0, s66
    s_sub_i32 s66, s66, 1
    v_mov_b32 v207, s66
    s_mov_b64 exec, 1
    buffer_store_dword v207, v202, s[28:31], s51 offen offset:128
L_glb_done:
    s_mov_b64 exec, -1
L_side_ret:
    s_cmp_eq_u32 s56, 0
    s_cbranch_scc1 L_side_ret0
    s_branch L_side_ret1
L_last:
    s_lshl_b32 s65, s3, 3
    s_add_u32 s65, s65, 159808
    v_add_f32_dpp v50, v9, v9 row_ror:8 row_mask:0xf bank_mask:0xf
    v_mov_b32 v189, s65
    v_mov_b32 v51, v50
    v_mov_b32 v52, v7
    s_nop 0
    v_permlane16_swap_b32 v51, v50
    v_add_f32 v50, v50, v51
    v_mov_b32 v51, v50
    s_nop 1
    v_permlane32_swap_b32 v51, v50
    v_add_f32 v53, v50, v51
    ds_write_b64 v189, v[52:53]
    s_waitcnt lgkmcnt(0)
    s_mov_b64 exec, 1
    ds_add_u32 v46, v188 offset:36
    s_mov_b64 exec, -1
    v_and_b32 v48, 3, v0
    v_lshlrev_b32 v48, 3, v48
    v_lshrrev_b32 v49, 2, v0
    v_and_b32 v50, 3, v49
    v_mul_u32_u24 v50, 160, v50
    v_add_u32 v48, v50, v48
    v_lshrrev_b32 v50, 4, v0
    v_mul_u32_u24 v49, 1280, v50
    v_add_u32 v48, v49, v48
    s_lshl_b32 s65, s3, 5
    s_add_u32 s65, s65, 122880
    v_add_u32 v49, s65, v48
    v_mov_b32 v192, v49
    ds_read_b64_tr_b16 v[112:113], v49 offset:0
    ds_read_b64_tr_b16 v[114:115], v49 offset:640
    ds_read_b64_tr_b16 v[116:117], v49 offset:5120
    ds_read_b64_tr_b16 v[118:119], v49 offset:5760
    ds_read_b64_tr_b16 v[120:121], v49 offset:10240
    ds_read_b64_tr_b16 v[122:123], v49 offset:10880
    ds_read_b64_tr_b16 v[124:125], v49 offset:15360
    ds_read_b64_tr_b16 v[126:127], v49 offset:16000
    v_and_b32 v48, 7, v0
    v_mul_u32_u24 v190, 400, v48
    v_lshl_add_u32 v190, v50, 4, v190
    v_add_u32 v190, 0, v190
    v_and_b32 v48, 1, v50
    v_lshrrev_b32 v49, 1, v50
    v_lshl_add_u32 v48, v48, 1, v49
    v_and_b32 v49, 15, v0
    v_lshlrev_b32 v49, 3, v49
    v_lshl_add_u32 v191, v48, 7, v49
    s_mul_i32 s57, s41, 40
    s_mul_i32 s65, s40, 5
    s_add_u32 s57, s57, s65
    s_add_u32 s57, s57, s3
    s_lshl_b32 s57, s57, 9
    s_add_u32 s57, s57, 98304
    v_mov_b32 v189, 159808
L_meet2:
    ds_read_b32 v63, v46 offset:36
    s_add_u32 s48, s48, 1
    s_waitcnt lgkmcnt(0)
    v_readfirstlane_b32 s65, v63
    s_cmp_gt_u32 s48, 16777216
    s_cselect_b32 s65, 4, s65
    s_cmp_lt_u32 s65, 4
    s_cbranch_scc1 L_meet2
    ds_read_b128 v[64:67], v189
    ds_read_b128 v[68:71], v189 offset:16
    ds_read_b32 v74, v46 offset:12
    s_waitcnt lgkmcnt(0)
    v_readfirstlane_b32 s100, v74
    v_max3_f32 v72, v64, v66, v68
    v_max_f32 v72, v72, v70
    v_sub_f32 v64, v64, v72
    v_sub_f32 v66, v66, v72
    v_sub_f32 v68, v68, v72
    v_sub_f32 v70, v70, v72
    v_sub_f32 v72, v7, v72
    v_exp_f32 v64, v64
    v_exp_f32 v66, v66
    v_exp_f32 v68, v68
    v_exp_f32 v70, v70
    v_exp_f32 v72, v72
    v_mul_f32 v73, v64, v65
    v_fmac_f32 v73, v66, v67
    v_fmac_f32 v73, v68, v69
    v_fmac_f32 v73, v70, v71
    v_rcp_f32 v73, v73
    s_mov_b32 s66, 153600
    v_mul_f32 v72, v72, v73
    v_mul_f32 v208, v208, v72
    v_mul_f32 v209, v209, v72
    v_mul_f32 v210, v210, v72
    v_mul_f32 v211, v211, v72
    v_mul_f32 v212, v212, v72
    v_mul_f32 v213, v213, v72
    v_mul_f32 v214, v214, v72
    v_mul_f32 v215, v215, v72
    v_mul_f32 v216, v216, v72
    v_mul_f32 v217, v217, v72
    v_mul_f32 v218, v218, v72
    v_mul_f32 v219, v219, v72
    v_mul_f32 v220, v220, v72
    v_mul_f32 v221, v221, v72
    v_mul_f32 v222, v222, v72
    v_mul_f32 v223, v223, v72
    v_mul_f32 v224, v224, v72
    v_mul_f32 v225, v225, v72
    v_mul_f32 v226, v226, v72
    v_mul_f32 v227, v227, v72
    v_mul_f32 v228, v228, v72
    v_mul_f32 v229, v229, v72
    v_mul_f32 v230, v230, v72
    v_mul_f32 v231, v231, v72
    v_mul_f32 v232, v232, v72
    v_mul_f32 v233, v233, v72
    v_mul_f32 v234, v234, v72
    v_mul_f32 v235, v235, v72
    v_mul_f32 v236, v236, v72
    v_mul_f32 v237, v237, v72
    v_mul_f32 v238, v238, v72
    v_mul_f32 v239, v239, v72
    v_mul_f32 v12, v12, v72
    v_mul_f32 v13, v13, v72
    v_mul_f32 v14, v14, v72
    v_mul_f32 v15, v15, v72
    v_mul_f32 v16, v16, v72
    v_mul_f32 v17, v17, v72
    v_mul_f32 v18, v18, v72
    v_mul_f32 v19, v19, v72
    v_mul_f32 v20, v20, v72
    v_mul_f32 v21, v21, v72
    v_mul_f32 v22, v22, v72
    v_mul_f32 v23, v23, v72
    v_lshl_add_u32 v74, v0, 4, s66
    v_lshlrev_b32 v75, 3, v0
    v_lshlrev_b32 v76, 4, v0
    s_sub_u32 s67, s3, 1
    s_lshl_b32 s66, s67, 6
    v_add_u32 v77, s66, v0
    v_mul_u32_u24 v78, 2731, v77
    v_lshrrev_b32 v78, 16, v78
    v_add_u32 v77, v77, v78
    v_lshlrev_b32 v77, 4, v77
    s_mul_i32 s58, s41, 3072
    s_lshl_b32 s66, s67, 10
    s_mul_i32 s67, s40, 384
    s_cmp_eq_u32 s3, 0
    s_cselect_b32 s66, s67, s66
    s_add_u32 s58, s58, s66
    s_branch L_vloop
L_done:
    s_nop 3
    s_mov_b32 exec_hi, 0
    ds_write_b128 v10, v[12:15]
    s_mov_b32 exec_lo, 0
    s_mov_b32 exec_hi, -1
    ds_write_b128 v10, v[20:23] offset:256
    s_mov_b32 exec_lo, 0x00ff00ff
    s_mov_b32 exec_hi, 0xff00ff00
    ds_write_b128 v11, v[16:19]
    s_mov_b64 exec, -1
    s_waitcnt lgkmcnt(0)
    s_barrier
    s_cmp_lg_u32 s3, 0
    s_cbranch_scc1 L_gather
    s_mov_b32 exec_hi, 0xffff
    ds_read_b128 v[208:211], v74 offset:0
    ds_read_b128 v[212:215], v74 offset:768
    ds_read_b128 v[216:219], v74 offset:1552
    ds_read_b128 v[220:223], v74 offset:2320
    ds_read_b128 v[224:227], v74 offset:3104
    ds_read_b128 v[228:231], v74 offset:3872
    ds_read_b128 v[232:235], v74 offset:4656
    ds_read_b128 v[236:239], v74 offset:5424
    s_waitcnt lgkmcnt(6)
    v_pk_add_f32 v[208:209], v[208:209], v[212:213]
    v_pk_add_f32 v[210:211], v[210:211], v[214:215]
    s_waitcnt lgkmcnt(4)
    v_pk_add_f32 v[216:217], v[216:217], v[220:221]
    v_pk_add_f32 v[218:219], v[218:219], v[222:223]
    v_pk_add_f32 v[208:209], v[208:209], v[216:217]
    v_pk_add_f32 v[210:211], v[210:211], v[218:219]
    s_waitcnt lgkmcnt(2)
    v_pk_add_f32 v[224:225], v[224:225], v[228:229]
    v_pk_add_f32 v[226:227], v[226:227], v[230:231]
    s_waitcnt lgkmcnt(0)
    v_pk_add_f32 v[232:233], v[232:233], v[236:237]
    v_pk_add_f32 v[234:235], v[234:235], v[238:239]
    v_pk_add_f32 v[224:225], v[224:225], v[232:233]
    v_pk_add_f32 v[226:227], v[226:227], v[234:235]
    v_pk_add_f32 v[208:209], v[208:209], v[224:225]
    v_pk_add_f32 v[210:211], v[210:211], v[226:227]
    v_cvt_pk_bf16_f32 v64, v208, v209
    v_cvt_pk_bf16_f32 v65, v210, v211
    v_min_u32 v64, 0xfffffffe, v64
    v_min_u32 v65, 0xfffffffe, v65
    s_cmp_eq_u32 s100, 1
    s_cbranch_scc0 L_slowst
    buffer_store_dwordx2 v[64:65], v75, s[28:31], s58 offen
    s_branch L_stdone
L_slowst:
    buffer_store_dwordx2 v[64:65], v75, s[28:31], s58 offen sc0 sc1
L_stdone:
    s_mov_b32 exec_hi, -1
    s_branch L_project
L_gather:
    s_cmp_eq_u32 s100, 1
    s_cbranch_scc0 L_slowld
    s_mov_b64 s[72:73], -1
    v_mov_b32 v208, -1
    v_mov_b32 v209, -1
    v_mov_b32 v210, -1
    v_mov_b32 v211, -1
L_pollf:
    s_mov_b64 exec, s[72:73]
    s_cbranch_execz L_pollf_0
    buffer_load_dwordx4 v[208:211], v76, s[28:31], s58 offen nt
L_pollf_0:
    s_mov_b64 exec, -1
    s_add_u32 s48, s48, 1
    s_waitcnt vmcnt(1)
    v_max3_u32 v64, v208, v209, v210
    v_max_u32 v64, v64, v211
    v_cmp_eq_u32 s[72:73], -1, v64
    s_cmp_gt_u32 s48, 16777216
    s_cbranch_scc1 L_pollf_done
    s_cmp_lg_u64 s[72:73], 0
    s_cbranch_scc1 L_pollf
L_pollf_done:
    s_branch L_lddone
L_slowld:
    s_mov_b64 s[72:73], -1
L_pollp:
    s_mov_b64 exec, s[72:73]
    s_cbranch_execz L_pollp_0
    buffer_load_dwordx4 v[208:211], v76, s[28:31], s58 offen sc0 sc1
L_pollp_0:
    s_mov_b64 exec, -1
    s_add_u32 s48, s48, 1
    s_waitcnt vmcnt(0)
    v_max3_u32 v64, v208, v209, v210
    v_max_u32 v64, v64, v211
    v_cmp_eq_u32 s[72:73], -1, v64
    s_cmp_gt_u32 s48, 16777216
    s_cbranch_scc1 L_pollp_done
    s_cmp_lg_u64 s[72:73], 0
    s_cbranch_scc1 L_pollp
L_pollp_done:
L_lddone:
    ds_write_b128 v77, v[208:211] offset:0
    s_branch L_project
L_tail:
    v_and_b32 v48, 3, v0
    v_lshlrev_b32 v48, 3, v48
    v_lshrrev_b32 v49, 2, v0
    v_and_b32 v50, 3, v49
    v_mul_u32_u24 v50, 160, v50
    v_add_u32 v48, v50, v48
    v_lshrrev_b32 v50, 4, v0
    v_mul_u32_u24 v49, 1280, v50
    v_add_u32 v48, v49, v48
    s_lshl_b32 s65, s3, 5
    s_add_u32 s65, s65, 122880
    v_add_u32 v49, s65, v48
    v_mov_b32 v192, v49
    ds_read_b64_tr_b16 v[112:113], v49 offset:0
    ds_read_b64_tr_b16 v[114:115], v49 offset:640
    ds_read_b64_tr_b16 v[116:117], v49 offset:5120
    ds_read_b64_tr_b16 v[118:119], v49 offset:5760
    ds_read_b64_tr_b16 v[120:121], v49 offset:10240
    ds_read_b64_tr_b16 v[122:123], v49 offset:10880
    ds_read_b64_tr_b16 v[124:125], v49 offset:15360
    ds_read_b64_tr_b16 v[126:127], v49 offset:16000
    v_and_b32 v48, 7, v0
    v_mul_u32_u24 v190, 400, v48
    v_lshl_add_u32 v190, v50, 4, v190
    v_add_u32 v190, 0, v190
    v_and_b32 v48, 1, v50
    v_lshrrev_b32 v49, 1, v50
    v_lshl_add_u32 v48, v48, 1, v49
    v_and_b32 v49, 15, v0
    v_lshlrev_b32 v49, 3, v49
    v_lshl_add_u32 v191, v48, 7, v49
    s_mul_i32 s57, s41, 40
    s_mul_i32 s65, s40, 5
    s_add_u32 s57, s57, s65
    s_add_u32 s57, s57, s3
    s_lshl_b32 s57, s57, 9
    s_add_u32 s57, s57, 98304
    s_and_b32 s59, s2, 3
    s_lshr_b32 s62, s2, 2
    v_lshrrev_b32 v52, 3, v0
    v_mul_u32_u24 v52, 20480, v52
    v_and_b32 v53, 7, v0
    v_lshl_add_u32 v52, v53, 4, v52
    s_lshl_b32 s65, s62, 9
    s_lshl_b32 s66, s59, 7
    s_add_u32 s65, s65, s66
    s_add_u32 s50, s65, 98304
    s_add_u32 s51, s50, 163840
    s_add_u32 s52, s50, 327680
    s_add_u32 s53, s50, 491520
    v_and_b32 v54, 1, v50
    v_mul_u32_u24 v54, 1280, v54
    v_lshl_add_u32 v54, v53, 2, v54
    v_lshrrev_b32 v53, 5, v0
    v_lshl_add_u32 v53, v53, 1, v54
    s_mul_i32 s59, s59, 2560
    s_lshl_b32 s62, s62, 5
    s_add_u32 s59, s59, s62
    s_barrier
    s_waitcnt vmcnt(0)
L_project:
    v_cmp_gt_u32 vcc, 32, v0
    s_waitcnt lgkmcnt(0)
    s_barrier
    ds_read_b128 v[136:139], v190 offset:0
    ds_read_b128 v[140:143], v190 offset:64
    ds_read_b128 v[144:147], v190 offset:128
    ds_read_b128 v[148:151], v190 offset:192
    ds_read_b128 v[152:155], v190 offset:256
    ds_read_b64_tr_b16 v[128:129], v192 offset:20480
    ds_read_b64_tr_b16 v[130:131], v192 offset:21120
    ds_read_b128 v[156:159], v190 offset:320
    ds_read_b64_tr_b16 v[132:133], v192 offset:25600
    ds_read_b64_tr_b16 v[134:135], v192 offset:26240
    s_waitcnt lgkmcnt(9)
    v_mfma_f32_16x16x32_bf16 v[12:15], v[136:139], v[112:115], 0
    s_waitcnt lgkmcnt(8)
    v_mfma_f32_16x16x32_bf16 v[12:15], v[140:143], v[116:119], v[12:15]
    s_waitcnt lgkmcnt(7)
    v_mfma_f32_16x16x32_bf16 v[12:15], v[144:147], v[120:123], v[12:15]
    s_waitcnt lgkmcnt(6)
    v_mfma_f32_16x16x32_bf16 v[12:15], v[148:151], v[124:127], v[12:15]
    s_waitcnt lgkmcnt(3)
    v_mfma_f32_16x16x32_bf16 v[12:15], v[152:155], v[128:131], v[12:15]
    s_waitcnt lgkmcnt(0)
    v_mfma_f32_16x16x32_bf16 v[12:15], v[156:159], v[132:135], v[12:15]
    s_nop 7
    v_cndmask_b32 v12, v14, v12, vcc
    v_cndmask_b32 v13, v15, v13, vcc
    v_min_u32 v12, 0xfffffffe, v12
    v_min_u32 v13, 0xfffffffe, v13
    buffer_store_dwordx2 v[12:13], v191, s[28:31], s57 offen sc0 sc1
    s_cmp_lg_u32 s3, 4
    s_cbranch_scc1 L_fini
    s_cmp_ge_u32 s2, 160
    s_cbranch_scc1 L_fini
    s_waitcnt vmcnt(0)
    s_mov_b64 s[72:73], -1
    s_mov_b64 s[74:75], -1
    s_mov_b64 s[76:77], -1
    s_mov_b64 s[78:79], -1
    v_mov_b32 v208, -1
    v_mov_b32 v209, -1
    v_mov_b32 v210, -1
    v_mov_b32 v211, -1
    v_mov_b32 v212, -1
    v_mov_b32 v213, -1
    v_mov_b32 v214, -1
    v_mov_b32 v215, -1
    v_mov_b32 v216, -1
    v_mov_b32 v217, -1
    v_mov_b32 v218, -1
    v_mov_b32 v219, -1
    v_mov_b32 v220, -1
    v_mov_b32 v221, -1
    v_mov_b32 v222, -1
    v_mov_b32 v223, -1
L_pollr:
    s_mov_b64 exec, s[72:73]
    s_cbranch_execz L_pollr_0
    buffer_load_dwordx4 v[208:211], v52, s[28:31], s50 offen sc0 sc1
L_pollr_0:
    s_mov_b64 exec, s[74:75]
    s_cbranch_execz L_pollr_1
    buffer_load_dwordx4 v[212:215], v52, s[28:31], s51 offen sc0 sc1
L_pollr_1:
    s_mov_b64 exec, s[76:77]
    s_cbranch_execz L_pollr_2
    buffer_load_dwordx4 v[216:219], v52, s[28:31], s52 offen sc0 sc1
L_pollr_2:
    s_mov_b64 exec, s[78:79]
    s_cbranch_execz L_pollr_3
    buffer_load_dwordx4 v[220:223], v52, s[28:31], s53 offen sc0 sc1
L_pollr_3:
    s_mov_b64 exec, -1
    s_add_u32 s48, s48, 1
    s_waitcnt vmcnt(4)
    v_max3_u32 v64, v208, v209, v210
    v_max3_u32 v65, v212, v213, v214
    v_max3_u32 v66, v216, v217, v218
    v_max3_u32 v67, v220, v221, v222
    v_max_u32 v64, v64, v211
    v_max_u32 v65, v65, v215
    v_max_u32 v66, v66, v219
    v_max_u32 v67, v67, v223
    v_cmp_eq_u32 s[72:73], -1, v64
    v_cmp_eq_u32 s[74:75], -1, v65
    v_cmp_eq_u32 s[76:77], -1, v66
    v_cmp_eq_u32 s[78:79], -1, v67
    s_cmp_gt_u32 s48, 16777216
    s_cbranch_scc1 L_pollr_done
    s_or_b64 s[60:61], s[72:73], s[74:75]
    s_or_b64 s[60:61], s[60:61], s[76:77]
    s_or_b64 s[60:61], s[60:61], s[78:79]
    s_cbranch_scc1 L_pollr
L_pollr_done:
    v_add_f32 v64, v208, v212
    v_add_f32 v65, v209, v213
    v_add_f32 v66, v210, v214
    v_add_f32 v67, v211, v215
    v_add_f32 v68, v216, v220
    v_add_f32 v69, v217, v221
    v_add_f32 v70, v218, v222
    v_add_f32 v71, v219, v223
    v_add_f32 v64, v64, v68
    v_add_f32 v65, v65, v69
    v_add_f32 v66, v66, v70
    v_add_f32 v67, v67, v71
    s_nop 0
    v_permlane32_swap_b32 v64, v66
    v_permlane32_swap_b32 v65, v67
    v_add_f32 v64, v64, v66
    v_add_f32 v65, v65, v67
    s_nop 1
    v_permlane16_swap_b32 v64, v65
    v_add_f32 v64, v64, v65
    s_nop 1
    v_add_f32_dpp v64, v64, v64 row_ror:8 row_mask:0xf bank_mask:0xf
    v_cvt_pk_bf16_f32 v64, v64, v64
    s_mov_b32 exec_lo, 0x00ff00ff
    s_mov_b32 exec_hi, 0x00ff00ff
    buffer_store_short v64, v53, s[36:39], s59 offen
    s_mov_b64 exec, -1
L_fini:
L_end:
    s_endpgm
.section .rodata,"a"
.p2align 6
.amdhsa_kernel standalone__mha_block_cached__sampling_kernel
  .amdhsa_next_free_vgpr 256
  .amdhsa_next_free_sgpr 102
  .amdhsa_accum_offset 256
  .amdhsa_group_segment_fixed_size 0
  .amdhsa_kernarg_size 64
  .amdhsa_user_sgpr_count 2
  .amdhsa_user_sgpr_kernarg_segment_ptr 1
  .amdhsa_system_sgpr_workgroup_id_x 1
  .amdhsa_float_denorm_mode_32 3
.end_amdhsa_kernel
```
